```python
import torch

def _softmax(x, axis=-1):
    return torch.softmax(x, dim=axis)
def _gelu(x):
    return torch.nn.functional.gelu(x, approximate="tanh")
def _silu(x):
    return torch.nn.functional.silu(x)
def _sigmoid(x):
    return torch.sigmoid(x)
def _layernorm(x, axis=-1, eps=1e-5):
    m = x.mean(dim=axis, keepdim=True)
    v = x.var(dim=axis, keepdim=True, unbiased=False)
    return (x - m) / torch.sqrt(v + eps)
def _scatter_add(tgt, idx, src, axis=0):
    return tgt.clone().index_add_(axis, idx, src)
def _segment_sum(src, seg, n):
    out = torch.zeros((n,) + src.shape[1:], dtype=src.dtype)
    return out.index_add_(0, seg, src)
def _pad(x, pw):
    flat = tuple(v for pair in reversed(pw) for v in pair)
    return torch.nn.functional.pad(x, flat)

kernel_name = 'concat_heads__gqa_block_cached__mha_block_cached__decode'

def setup_inputs():

    _w = (lambda a: (lambda t: t.to(torch.bfloat16) if t.is_floating_point() else t)(torch.as_tensor(a)))
    def _A_setup():
        B, Sq, D = 4, 1, 448
        Hq, Hkv, Sk, Dh = 16, 8, 16384, 256
        assert Hq % Hkv == 0, (Hq, Hkv)
        return {
            "x": _w((lambda *s: torch.randn(*s, dtype=torch.bfloat16) * 0.8)(B, Sq, D)),
            "k_cache": _w((lambda *s: torch.randn(*s, dtype=torch.bfloat16) * 0.8)(B, Hkv, Sk, Dh)),
            "v_cache": _w((lambda *s: torch.randn(*s, dtype=torch.bfloat16) * 0.05)(B, Hkv, Sk, Dh)),
            "wq": _w((lambda *s: torch.randn(*s, dtype=torch.bfloat16) * 0.8)(D, Hq * Dh) * (D ** -0.5)),
            "wo": _w((lambda *s: torch.randn(*s, dtype=torch.bfloat16) * 0.05)(Hq * Dh, D) * ((Hq * Dh) ** -0.5)),
        }
    _A_in = _A_setup()

    def _B_setup():
        B, Sq, D = 4, 1, 448
        H, Sk, Dh = 16, 16384, 256
        return {
            "x": _w((lambda *s: torch.randn(*s, dtype=torch.bfloat16) * 0.8)(B, Sq, D)),
            "k_cache": _w((lambda *s: torch.randn(*s, dtype=torch.bfloat16) * 0.8)(B, H, Sk, Dh)),
            "v_cache": _w((lambda *s: torch.randn(*s, dtype=torch.bfloat16) * 0.05)(B, H, Sk, Dh)),
            "wq": _w((lambda *s: torch.randn(*s, dtype=torch.bfloat16) * 0.8)(D, H * Dh) * (D ** -0.5)),
            "wo": _w((lambda *s: torch.randn(*s, dtype=torch.bfloat16) * 0.05)(H * Dh, D) * ((H * Dh) ** -0.5)),
        }
    _B_in = _B_setup()

    return {
        "A_x": _A_in["x"],
        "A_k_cache": _A_in["k_cache"],
        "A_v_cache": _A_in["v_cache"],
        "A_wq": _A_in["wq"],
        "A_wo": _A_in["wo"],
        "B_x": _B_in["x"],
        "B_k_cache": _B_in["k_cache"],
        "B_v_cache": _B_in["v_cache"],
        "B_wq": _B_in["wq"],
        "B_wo": _B_in["wo"],
    }

def reference(A_x, A_k_cache, A_v_cache, A_wq, A_wo, B_x, B_k_cache, B_v_cache, B_wq, B_wo):
    def _A_ref(x, k_cache, v_cache, wq, wo):
        B, Sq, D = x.shape
        Hq, Dh = 16, 256
        Hkv = k_cache.shape[1]
        rep = Hq // Hkv
        q = (lambda x, *d: x.permute(*d))((x @ wq).reshape(B, Sq, Hq, Dh), 0, 2, 1, 3)
        k = (lambda x, n, axis: torch.repeat_interleave(x, n, dim=axis))(k_cache, rep, axis=1)
        v = (lambda x, n, axis: torch.repeat_interleave(x, n, dim=axis))(v_cache, rep, axis=1)
        scores = torch.einsum("bhqd,bhkd->bhqk", q, k) * (Dh ** -0.5)
        p = _softmax(scores, axis=-1)
        o = torch.einsum("bhqk,bhkd->bhqd", p, v)
        return (lambda x, *d: x.permute(*d))(o, 0, 2, 1, 3).reshape(B, Sq, Hq * Dh) @ wo

    def _B_ref(x, k_cache, v_cache, wq, wo):
        B, Sq, D = x.shape
        H, Dh = 16, 256
        q = (lambda x, *d: x.permute(*d))((x @ wq).reshape(B, Sq, H, Dh), 0, 2, 1, 3)
        scores = torch.einsum("bhqd,bhkd->bhqk", q, k_cache) * (Dh ** -0.5)
        p = _softmax(scores, axis=-1)
        o = torch.einsum("bhqk,bhkd->bhqd", p, v_cache)
        return (lambda x, *d: x.permute(*d))(o, 0, 2, 1, 3).reshape(B, Sq, H * Dh) @ wo

    a = _A_ref(A_x, A_k_cache, A_v_cache, A_wq, A_wo)
    b = _B_ref(B_x, B_k_cache, B_v_cache, B_wq, B_wo)
    return torch.concatenate([a, b], axis=-1)
```

```asm
; @launch grid=(256,1,1) block=(320,1,1) lds=57856
.amdgcn_target "amdgcn-amd-amdhsa--gfx950"
.text
.globl concat_heads__gqa_block_cached__mha_block_cached__decode_kernel
.p2align 8
.type concat_heads__gqa_block_cached__mha_block_cached__decode_kernel,@function
concat_heads__gqa_block_cached__mha_block_cached__decode_kernel:
  s_cmp_ge_u32 s2, 256
  s_cbranch_scc1 L_exit_m
  s_lshr_b32 s44, s2, 7
  s_mul_i32 s45, s44, 40
  s_add_u32 s46, s0, s45
  s_addc_u32 s47, s1, 0
  s_load_dwordx2 s[48:49], s[46:47], 0
  s_load_dwordx2 s[52:53], s[46:47], 24
  s_lshr_b32 s84, s2, 3
  s_and_b32 s85, s2, 7
  s_lshr_b32 s82, s84, 1
  s_and_b32 s82, s82, 7
  s_lshl_b32 s82, s82, 4
  s_lshl_b32 s86, s85, 1
  s_or_b32 s82, s82, s86
  s_and_b32 s86, s84, 1
  s_or_b32 s82, s82, s86
  s_and_b32 s86, s2, 128
  s_or_b32 s82, s82, s86
  s_lshr_b32 s83, s84, 2
  s_lshl_b32 s83, s83, 3
  s_add_u32 s83, s83, s85
  s_lshl_b32 s83, s83, 2
  s_and_b32 s86, s84, 3
  s_or_b32 s83, s83, s86
  s_load_dwordx2 s[16:17], s[0:1], 8
  s_load_dwordx2 s[18:19], s[0:1], 16
  s_load_dwordx2 s[20:21], s[0:1], 48
  s_load_dwordx2 s[22:23], s[0:1], 56
  s_load_dwordx2 s[28:29], s[0:1], 80
  s_load_dwordx2 s[26:27], s[0:1], 88
  s_load_dwordx2 s[24:25], s[0:1], 96
  v_lshrrev_b32 v1, 6, v0
  v_and_b32 v6, 63, v0
  s_nop 0
  v_readfirstlane_b32 s3, v1
  s_lshr_b32 s4, s2, 3
  s_and_b32 s5, s2, 7
  s_waitcnt lgkmcnt(0)
  s_load_dword s6, s[24:25], 0
  s_cmp_eq_u32 s3, 4
  s_cbranch_scc1 L_aux_m
  v_and_b32 v1, 15, v6
  v_lshlrev_b32 v1, 9, v1
  v_lshrrev_b32 v12, 4, v6
  v_lshl_add_u32 v1, v12, 4, v1
  v_lshrrev_b32 v12, 5, v6
  v_lshlrev_b32 v12, 12, v12
  v_and_b32 v2, 31, v6
  v_lshl_add_u32 v2, v2, 4, v12
  s_lshl_b32 s46, s4, 1
  s_lshl_b32 s44, s46, 23
  s_lshr_b32 s45, s46, 9
  s_add_u32 s8, s20, s44
  s_addc_u32 s9, s21, s45
  s_and_b32 s9, s9, 0xffff
  s_add_u32 s12, s22, s44
  s_addc_u32 s13, s23, s45
  s_and_b32 s13, s13, 0xffff
  s_mov_b32 s10, 0x800000
  s_mov_b32 s14, 0x800000
  s_mov_b32 s11, 0x20000
  s_mov_b32 s15, 0x20000
  s_lshl_b32 s31, s5, 20
  s_mul_i32 s42, s2, 0
  s_mov_b32 s44, s3
  s_lshl_b32 s44, s44, 13
  s_add_u32 s30, s44, s31
  s_lshl_b32 s34, s3, 14
  s_add_u32 s34, s34, 57856
  s_barrier
  buffer_load_dwordx4 a[0:3], v1, s[8:11], s30 offen offset:0 nt
  buffer_load_dwordx4 a[4:7], v1, s[8:11], s30 offen offset:64 nt
  buffer_load_dwordx4 a[8:11], v1, s[8:11], s30 offen offset:128 nt
  buffer_load_dwordx4 a[12:15], v1, s[8:11], s30 offen offset:192 nt
  buffer_load_dwordx4 a[16:19], v1, s[8:11], s30 offen offset:256 nt
  buffer_load_dwordx4 a[20:23], v1, s[8:11], s30 offen offset:320 nt
  buffer_load_dwordx4 a[24:27], v1, s[8:11], s30 offen offset:384 nt
  buffer_load_dwordx4 a[28:31], v1, s[8:11], s30 offen offset:448 nt
  buffer_load_dwordx4 v[72:75], v2, s[12:15], s30 offen offset:0 nt
  buffer_load_dwordx4 v[76:79], v2, s[12:15], s30 offen offset:512 nt
  buffer_load_dwordx4 v[80:83], v2, s[12:15], s30 offen offset:1024 nt
  buffer_load_dwordx4 v[84:87], v2, s[12:15], s30 offen offset:1536 nt
  buffer_load_dwordx4 v[88:91], v2, s[12:15], s30 offen offset:2048 nt
  buffer_load_dwordx4 v[92:95], v2, s[12:15], s30 offen offset:2560 nt
  buffer_load_dwordx4 v[96:99], v2, s[12:15], s30 offen offset:3072 nt
  buffer_load_dwordx4 v[100:103], v2, s[12:15], s30 offen offset:3584 nt
  s_add_u32 s44, s3, 4
  s_lshl_b32 s44, s44, 13
  s_add_u32 s30, s44, s31
  buffer_load_dwordx4 a[32:35], v1, s[8:11], s30 offen offset:0 nt
  buffer_load_dwordx4 a[36:39], v1, s[8:11], s30 offen offset:64 nt
  buffer_load_dwordx4 a[40:43], v1, s[8:11], s30 offen offset:128 nt
  buffer_load_dwordx4 a[44:47], v1, s[8:11], s30 offen offset:192 nt
  buffer_load_dwordx4 a[48:51], v1, s[8:11], s30 offen offset:256 nt
  buffer_load_dwordx4 a[52:55], v1, s[8:11], s30 offen offset:320 nt
  buffer_load_dwordx4 a[56:59], v1, s[8:11], s30 offen offset:384 nt
  buffer_load_dwordx4 a[60:63], v1, s[8:11], s30 offen offset:448 nt
  s_waitcnt vmcnt(16)
  buffer_load_dwordx4 v[104:107], v2, s[12:15], s30 offen offset:0 nt
  buffer_load_dwordx4 v[108:111], v2, s[12:15], s30 offen offset:512 nt
  buffer_load_dwordx4 v[112:115], v2, s[12:15], s30 offen offset:1024 nt
  buffer_load_dwordx4 v[116:119], v2, s[12:15], s30 offen offset:1536 nt
  buffer_load_dwordx4 v[120:123], v2, s[12:15], s30 offen offset:2048 nt
  buffer_load_dwordx4 v[124:127], v2, s[12:15], s30 offen offset:2560 nt
  buffer_load_dwordx4 v[128:131], v2, s[12:15], s30 offen offset:3072 nt
  buffer_load_dwordx4 v[132:135], v2, s[12:15], s30 offen offset:3584 nt
  s_mov_b32 s32, 0
  s_mov_b32 s37, 0
  s_mov_b32 s87, 0
  s_mov_b32 s90, s3
  s_mov_b32 s91, 0
  s_mov_b32 s94, -1
  s_mov_b32 s95, 1
  s_mov_b32 s93, 0
  s_lshl_b32 s89, s4, 2
  s_add_u32 s89, s89, s3
  s_mul_i32 s89, s89, 4352
  s_add_u32 s89, s89, 2359296
  s_mov_b32 s38, 0x3db8aa3b
  s_mov_b32 s39, 0x05040100
  s_mov_b32 s40, 0x07060302
  s_waitcnt lgkmcnt(0)
  s_add_u32 s6, s6, 1
  s_and_b32 s44, s6, 0xff
  s_add_u32 s7, s44, 0x35
  s_and_b32 s7, s7, 0xff
  s_lshl_b32 s7, s7, 8
  s_or_b32 s7, s7, s44
  s_add_u32 s45, s44, 0x6b
  s_and_b32 s45, s45, 0xff
  s_lshl_b32 s45, s45, 16
  s_or_b32 s7, s7, s45
  s_add_u32 s45, s44, 0xa1
  s_lshl_b32 s45, s45, 24
  s_or_b32 s7, s7, s45
  v_mov_b32 v3, 0xff800000
  v_mov_b32 v4, 0xff800000
  v_mov_b32 v5, 0
  v_mov_b32 v40, 0
  v_mov_b32 v41, 0
  v_mov_b32 v42, 0
  v_mov_b32 v43, 0
  v_mov_b32 v44, 0
  v_mov_b32 v45, 0
  v_mov_b32 v46, 0
  v_mov_b32 v47, 0
  v_mov_b32 v48, 0
  v_mov_b32 v49, 0
  v_mov_b32 v50, 0
  v_mov_b32 v51, 0
  v_mov_b32 v52, 0
  v_mov_b32 v53, 0
  v_mov_b32 v54, 0
  v_mov_b32 v55, 0
  v_mov_b32 v56, 0
  v_mov_b32 v57, 0
  v_mov_b32 v58, 0
  v_mov_b32 v59, 0
  v_mov_b32 v60, 0
  v_mov_b32 v61, 0
  v_mov_b32 v62, 0
  v_mov_b32 v63, 0
  v_mov_b32 v64, 0
  v_mov_b32 v65, 0
  v_mov_b32 v66, 0
  v_mov_b32 v67, 0
  v_mov_b32 v68, 0
  v_mov_b32 v69, 0
  v_mov_b32 v70, 0
  v_mov_b32 v71, 0
  s_barrier
  v_and_b32 v12, 1, v6
  s_cmp_eq_u32 s37, 2
  s_cselect_b32 s44, 512, 0
  v_mul_u32_u24 v12, s44, v12
  s_lshl_b32 s44, s37, 9
  s_add_u32 s44, s44, 28672
  v_add_u32 v12, s44, v12
  v_lshrrev_b32 v13, 4, v6
  v_lshl_add_u32 v12, v13, 4, v12
  ds_read_b128 a[64:67], v12 offset:0
  ds_read_b128 a[68:71], v12 offset:64
  ds_read_b128 a[72:75], v12 offset:128
  ds_read_b128 a[76:79], v12 offset:192
  ds_read_b128 a[80:83], v12 offset:256
  ds_read_b128 a[84:87], v12 offset:320
  ds_read_b128 a[88:91], v12 offset:384
  ds_read_b128 a[92:95], v12 offset:448
  s_waitcnt lgkmcnt(0)
L_body_s0_m:
  s_cmp_eq_u32 s87, 0
  s_cbranch_scc1 L_st_s0_m
  s_mov_b32 s88, 1
  s_atomic_add s88, s[24:25], s89 glc
  s_waitcnt vmcnt(24)
  s_branch L_mf_s0_m
L_st_s0_m:
  s_waitcnt vmcnt(24)
  v_mov_b32 v13, 55568
  v_mov_b32 v14, 1
  s_mov_b64 exec, 1
  ds_add_rtn_u32 v12, v13, v14
  s_mov_b64 exec, -1
L_mf_s0_m:
  v_mfma_f32_16x16x32_bf16 v[8:11], a[0:3], a[64:67], 0
  v_mfma_f32_16x16x32_bf16 v[8:11], a[4:7], a[68:71], v[8:11]
  v_mfma_f32_16x16x32_bf16 v[8:11], a[8:11], a[72:75], v[8:11]
  v_mfma_f32_16x16x32_bf16 v[8:11], a[12:15], a[76:79], v[8:11]
  v_mfma_f32_16x16x32_bf16 v[8:11], a[16:19], a[80:83], v[8:11]
  v_mfma_f32_16x16x32_bf16 v[8:11], a[20:23], a[84:87], v[8:11]
  v_mfma_f32_16x16x32_bf16 v[8:11], a[24:27], a[88:91], v[8:11]
  v_mfma_f32_16x16x32_bf16 v[8:11], a[28:31], a[92:95], v[8:11]
  s_waitcnt lgkmcnt(0)
  s_cmp_eq_u32 s87, 0
  s_cbranch_scc0 L_wd_s0_m
  s_waitcnt lgkmcnt(0)
  v_readfirstlane_b32 s44, v12
  s_nop 0
  s_lshr_b32 s45, s44, 7
  s_min_u32 s45, s45, 2
  s_cmp_eq_u32 s45, s32
  s_cbranch_scc0 L_newph_s0_m
L_phok_s0_m:
  s_cmp_ge_u32 s44, 368
  s_cbranch_scc1 L_dyn_s0_m
  s_and_b32 s44, s44, 127
  s_lshl_b32 s44, s44, 13
  s_add_u32 s30, s44, s31
L_dyn_done_s0_m:
  s_mov_b32 s35, s32
  buffer_load_dwordx4 a[0:3], v1, s[8:11], s30 offen offset:0 nt
  buffer_load_dwordx4 a[4:7], v1, s[8:11], s30 offen offset:64 nt
  buffer_load_dwordx4 a[8:11], v1, s[8:11], s30 offen offset:128 nt
  buffer_load_dwordx4 a[12:15], v1, s[8:11], s30 offen offset:192 nt
  buffer_load_dwordx4 a[16:19], v1, s[8:11], s30 offen offset:256 nt
  buffer_load_dwordx4 a[20:23], v1, s[8:11], s30 offen offset:320 nt
  buffer_load_dwordx4 a[24:27], v1, s[8:11], s30 offen offset:384 nt
  buffer_load_dwordx4 a[28:31], v1, s[8:11], s30 offen offset:448 nt
  v_max3_f32 v12, v8, v9, v10
  v_max_f32 v12, v12, v11
  v_mov_b32 v13, v12
  s_nop 1
  v_permlane16_swap_b32 v12, v13
  v_max_f32 v12, v12, v13
  v_mov_b32 v13, v12
  s_nop 1
  v_permlane32_swap_b32 v12, v13
  v_max_f32 v12, v12, v13
  v_cmp_gt_f32 vcc, v12, v3
  s_cbranch_vccnz L_rare_s0_m
L_back_s0_m:
  v_fma_f32 v14, v8, s38, -v4
  v_fma_f32 v15, v9, s38, -v4
  v_fma_f32 v16, v10, s38, -v4
  v_fma_f32 v17, v11, s38, -v4
  v_exp_f32 v14, v14
  v_exp_f32 v15, v15
  v_exp_f32 v16, v16
  v_exp_f32 v17, v17
  v_add_f32 v18, v14, v15
  v_cvt_pk_bf16_f32 v20, v14, v15
  v_add_f32 v19, v16, v17
  v_cvt_pk_bf16_f32 v21, v16, v17
  v_add_f32 v18, v18, v19
  v_mov_b32 v22, v20
  v_mov_b32 v23, v21
  v_add_f32 v5, v5, v18
  s_nop 0
  v_permlane16_swap_b32 v20, v22
  v_permlane16_swap_b32 v21, v23
  s_waitcnt vmcnt(24)
  v_perm_b32 v24, v76, v72, s39
  v_perm_b32 v25, v84, v80, s39
  v_perm_b32 v26, v76, v72, s40
  v_perm_b32 v27, v84, v80, s40
  v_perm_b32 v28, v77, v73, s39
  v_perm_b32 v29, v85, v81, s39
  v_perm_b32 v30, v77, v73, s40
  v_perm_b32 v31, v85, v81, s40
  v_perm_b32 v32, v78, v74, s39
  v_perm_b32 v33, v86, v82, s39
  v_perm_b32 v34, v78, v74, s40
  v_perm_b32 v35, v86, v82, s40
  v_perm_b32 v36, v79, v75, s39
  v_perm_b32 v37, v87, v83, s39
  v_perm_b32 v38, v79, v75, s40
  v_perm_b32 v39, v87, v83, s40
  v_mfma_f32_4x4x4_16b_bf16 v[40:43], v[20:21], v[24:25], v[40:43]
  v_mfma_f32_4x4x4_16b_bf16 v[44:47], v[20:21], v[26:27], v[44:47]
  v_mfma_f32_4x4x4_16b_bf16 v[48:51], v[20:21], v[28:29], v[48:51]
  v_mfma_f32_4x4x4_16b_bf16 v[52:55], v[20:21], v[30:31], v[52:55]
  v_mfma_f32_4x4x4_16b_bf16 v[56:59], v[20:21], v[32:33], v[56:59]
  v_mfma_f32_4x4x4_16b_bf16 v[60:63], v[20:21], v[34:35], v[60:63]
  v_mfma_f32_4x4x4_16b_bf16 v[64:67], v[20:21], v[36:37], v[64:67]
  v_mfma_f32_4x4x4_16b_bf16 v[68:71], v[20:21], v[38:39], v[68:71]
  v_perm_b32 v24, v92, v88, s39
  v_perm_b32 v25, v100, v96, s39
  v_perm_b32 v26, v92, v88, s40
  v_perm_b32 v27, v100, v96, s40
  v_perm_b32 v28, v93, v89, s39
  v_perm_b32 v29, v101, v97, s39
  v_perm_b32 v30, v93, v89, s40
  v_perm_b32 v31, v101, v97, s40
  v_perm_b32 v32, v94, v90, s39
  v_perm_b32 v33, v102, v98, s39
  v_perm_b32 v34, v94, v90, s40
  v_perm_b32 v35, v102, v98, s40
  v_perm_b32 v36, v95, v91, s39
  v_perm_b32 v37, v103, v99, s39
  v_perm_b32 v38, v95, v91, s40
  v_perm_b32 v39, v103, v99, s40
  v_mfma_f32_4x4x4_16b_bf16 v[40:43], v[22:23], v[24:25], v[40:43]
  v_mfma_f32_4x4x4_16b_bf16 v[44:47], v[22:23], v[26:27], v[44:47]
  v_mfma_f32_4x4x4_16b_bf16 v[48:51], v[22:23], v[28:29], v[48:51]
  v_mfma_f32_4x4x4_16b_bf16 v[52:55], v[22:23], v[30:31], v[52:55]
  v_mfma_f32_4x4x4_16b_bf16 v[56:59], v[22:23], v[32:33], v[56:59]
  v_mfma_f32_4x4x4_16b_bf16 v[60:63], v[22:23], v[34:35], v[60:63]
  v_mfma_f32_4x4x4_16b_bf16 v[64:67], v[22:23], v[36:37], v[64:67]
  v_mfma_f32_4x4x4_16b_bf16 v[68:71], v[22:23], v[38:39], v[68:71]
  buffer_load_dwordx4 v[72:75], v2, s[12:15], s30 offen offset:0 nt
  buffer_load_dwordx4 v[76:79], v2, s[12:15], s30 offen offset:512 nt
  buffer_load_dwordx4 v[80:83], v2, s[12:15], s30 offen offset:1024 nt
  buffer_load_dwordx4 v[84:87], v2, s[12:15], s30 offen offset:1536 nt
  buffer_load_dwordx4 v[88:91], v2, s[12:15], s30 offen offset:2048 nt
  buffer_load_dwordx4 v[92:95], v2, s[12:15], s30 offen offset:2560 nt
  buffer_load_dwordx4 v[96:99], v2, s[12:15], s30 offen offset:3072 nt
  buffer_load_dwordx4 v[100:103], v2, s[12:15], s30 offen offset:3584 nt
L_body_s1_m:
  s_waitcnt vmcnt(24)
  v_mfma_f32_16x16x32_bf16 v[8:11], a[32:35], a[64:67], 0
  v_mfma_f32_16x16x32_bf16 v[8:11], a[36:39], a[68:71], v[8:11]
  v_mfma_f32_16x16x32_bf16 v[8:11], a[40:43], a[72:75], v[8:11]
  v_mfma_f32_16x16x32_bf16 v[8:11], a[44:47], a[76:79], v[8:11]
  v_mfma_f32_16x16x32_bf16 v[8:11], a[48:51], a[80:83], v[8:11]
  v_mfma_f32_16x16x32_bf16 v[8:11], a[52:55], a[84:87], v[8:11]
  v_mfma_f32_16x16x32_bf16 v[8:11], a[56:59], a[88:91], v[8:11]
  v_mfma_f32_16x16x32_bf16 v[8:11], a[60:63], a[92:95], v[8:11]
  s_nop 7
  v_max3_f32 v12, v8, v9, v10
  v_max_f32 v12, v12, v11
  v_mov_b32 v13, v12
  s_nop 1
  v_permlane16_swap_b32 v12, v13
  v_max_f32 v12, v12, v13
  v_mov_b32 v13, v12
  s_nop 1
  v_permlane32_swap_b32 v12, v13
  v_max_f32 v12, v12, v13
  v_cmp_gt_f32 vcc, v12, v3
  s_cbranch_vccnz L_rare_s1_m
L_back_s1_m:
  v_fma_f32 v14, v8, s38, -v4
  v_fma_f32 v15, v9, s38, -v4
  v_fma_f32 v16, v10, s38, -v4
  v_fma_f32 v17, v11, s38, -v4
  v_exp_f32 v14, v14
  v_exp_f32 v15, v15
  v_exp_f32 v16, v16
  v_exp_f32 v17, v17
  v_add_f32 v18, v14, v15
  v_cvt_pk_bf16_f32 v20, v14, v15
  v_add_f32 v19, v16, v17
  v_cvt_pk_bf16_f32 v21, v16, v17
  v_add_f32 v18, v18, v19
  v_mov_b32 v22, v20
  v_mov_b32 v23, v21
  v_add_f32 v5, v5, v18
  s_nop 0
  v_permlane16_swap_b32 v20, v22
  v_permlane16_swap_b32 v21, v23
  s_waitcnt vmcnt(16)
  v_perm_b32 v24, v108, v104, s39
  v_perm_b32 v25, v116, v112, s39
  v_perm_b32 v26, v108, v104, s40
  v_perm_b32 v27, v116, v112, s40
  v_perm_b32 v28, v109, v105, s39
  v_perm_b32 v29, v117, v113, s39
  v_perm_b32 v30, v109, v105, s40
  v_perm_b32 v31, v117, v113, s40
  v_perm_b32 v32, v110, v106, s39
  v_perm_b32 v33, v118, v114, s39
  v_perm_b32 v34, v110, v106, s40
  v_perm_b32 v35, v118, v114, s40
  v_perm_b32 v36, v111, v107, s39
  v_perm_b32 v37, v119, v115, s39
  v_perm_b32 v38, v111, v107, s40
  v_perm_b32 v39, v119, v115, s40
  v_mfma_f32_4x4x4_16b_bf16 v[40:43], v[20:21], v[24:25], v[40:43]
  v_mfma_f32_4x4x4_16b_bf16 v[44:47], v[20:21], v[26:27], v[44:47]
  v_mfma_f32_4x4x4_16b_bf16 v[48:51], v[20:21], v[28:29], v[48:51]
  v_mfma_f32_4x4x4_16b_bf16 v[52:55], v[20:21], v[30:31], v[52:55]
  v_mfma_f32_4x4x4_16b_bf16 v[56:59], v[20:21], v[32:33], v[56:59]
  v_mfma_f32_4x4x4_16b_bf16 v[60:63], v[20:21], v[34:35], v[60:63]
  v_mfma_f32_4x4x4_16b_bf16 v[64:67], v[20:21], v[36:37], v[64:67]
  v_mfma_f32_4x4x4_16b_bf16 v[68:71], v[20:21], v[38:39], v[68:71]
  v_perm_b32 v24, v124, v120, s39
  v_perm_b32 v25, v132, v128, s39
  v_perm_b32 v26, v124, v120, s40
  v_perm_b32 v27, v132, v128, s40
  v_perm_b32 v28, v125, v121, s39
  v_perm_b32 v29, v133, v129, s39
  v_perm_b32 v30, v125, v121, s40
  v_perm_b32 v31, v133, v129, s40
  v_perm_b32 v32, v126, v122, s39
  v_perm_b32 v33, v134, v130, s39
  v_perm_b32 v34, v126, v122, s40
  v_perm_b32 v35, v134, v130, s40
  v_perm_b32 v36, v127, v123, s39
  v_perm_b32 v37, v135, v131, s39
  v_perm_b32 v38, v127, v123, s40
  v_perm_b32 v39, v135, v131, s40
  v_mfma_f32_4x4x4_16b_bf16 v[40:43], v[22:23], v[24:25], v[40:43]
  v_mfma_f32_4x4x4_16b_bf16 v[44:47], v[22:23], v[26:27], v[44:47]
  v_mfma_f32_4x4x4_16b_bf16 v[48:51], v[22:23], v[28:29], v[48:51]
  v_mfma_f32_4x4x4_16b_bf16 v[52:55], v[22:23], v[30:31], v[52:55]
  v_mfma_f32_4x4x4_16b_bf16 v[56:59], v[22:23], v[32:33], v[56:59]
  v_mfma_f32_4x4x4_16b_bf16 v[60:63], v[22:23], v[34:35], v[60:63]
  v_mfma_f32_4x4x4_16b_bf16 v[64:67], v[22:23], v[36:37], v[64:67]
  v_mfma_f32_4x4x4_16b_bf16 v[68:71], v[22:23], v[38:39], v[68:71]
  s_mov_b32 s41, s32
  s_cmp_eq_u32 s41, s37
  s_mov_b32 s33, 0
  s_cbranch_scc0 L_flush_m
  s_branch L_body_b0_m
L_body_b0_m:
  s_cmp_eq_u32 s87, 0
  s_cbranch_scc1 L_st_b0_m
  s_mov_b32 s88, 1
  s_atomic_add s88, s[24:25], s89 glc
  s_waitcnt vmcnt(8)
  s_branch L_mf_b0_m
L_st_b0_m:
  s_waitcnt vmcnt(8)
  v_mov_b32 v13, 55568
  v_mov_b32 v14, 1
  s_mov_b64 exec, 1
  ds_add_rtn_u32 v12, v13, v14
  s_mov_b64 exec, -1
L_mf_b0_m:
  v_mfma_f32_16x16x32_bf16 v[8:11], a[0:3], a[64:67], 0
  v_mfma_f32_16x16x32_bf16 v[8:11], a[4:7], a[68:71], v[8:11]
  v_mfma_f32_16x16x32_bf16 v[8:11], a[8:11], a[72:75], v[8:11]
  v_mfma_f32_16x16x32_bf16 v[8:11], a[12:15], a[76:79], v[8:11]
  v_mfma_f32_16x16x32_bf16 v[8:11], a[16:19], a[80:83], v[8:11]
  v_mfma_f32_16x16x32_bf16 v[8:11], a[20:23], a[84:87], v[8:11]
  v_mfma_f32_16x16x32_bf16 v[8:11], a[24:27], a[88:91], v[8:11]
  v_mfma_f32_16x16x32_bf16 v[8:11], a[28:31], a[92:95], v[8:11]
  s_waitcnt lgkmcnt(0)
  s_cmp_eq_u32 s87, 0
  s_cbranch_scc0 L_wd_b0_m
  s_waitcnt lgkmcnt(0)
  v_readfirstlane_b32 s44, v12
  s_nop 0
  s_lshr_b32 s45, s44, 7
  s_min_u32 s45, s45, 2
  s_cmp_eq_u32 s45, s32
  s_cbranch_scc0 L_newph_b0_m
L_phok_b0_m:
  s_cmp_ge_u32 s44, 368
  s_cbranch_scc1 L_dyn_b0_m
  s_and_b32 s44, s44, 127
  s_lshl_b32 s44, s44, 13
  s_add_u32 s30, s44, s31
L_dyn_done_b0_m:
  s_mov_b32 s36, s32
  buffer_load_dwordx4 a[32:35], v1, s[8:11], s30 offen offset:0 nt
  buffer_load_dwordx4 a[36:39], v1, s[8:11], s30 offen offset:64 nt
  buffer_load_dwordx4 a[40:43], v1, s[8:11], s30 offen offset:128 nt
  buffer_load_dwordx4 a[44:47], v1, s[8:11], s30 offen offset:192 nt
  buffer_load_dwordx4 a[48:51], v1, s[8:11], s30 offen offset:256 nt
  buffer_load_dwordx4 a[52:55], v1, s[8:11], s30 offen offset:320 nt
  buffer_load_dwordx4 a[56:59], v1, s[8:11], s30 offen offset:384 nt
  buffer_load_dwordx4 a[60:63], v1, s[8:11], s30 offen offset:448 nt
  buffer_load_dwordx4 v[104:107], v2, s[12:15], s30 offen offset:0 nt
  buffer_load_dwordx4 v[108:111], v2, s[12:15], s30 offen offset:512 nt
  buffer_load_dwordx4 v[112:115], v2, s[12:15], s30 offen offset:1024 nt
  buffer_load_dwordx4 v[116:119], v2, s[12:15], s30 offen offset:1536 nt
  buffer_load_dwordx4 v[120:123], v2, s[12:15], s30 offen offset:2048 nt
  buffer_load_dwordx4 v[124:127], v2, s[12:15], s30 offen offset:2560 nt
  buffer_load_dwordx4 v[128:131], v2, s[12:15], s30 offen offset:3072 nt
  buffer_load_dwordx4 v[132:135], v2, s[12:15], s30 offen offset:3584 nt
  v_max3_f32 v12, v8, v9, v10
  v_max_f32 v12, v12, v11
  v_mov_b32 v13, v12
  s_nop 1
  v_permlane16_swap_b32 v12, v13
  v_max_f32 v12, v12, v13
  v_mov_b32 v13, v12
  s_nop 1
  v_permlane32_swap_b32 v12, v13
  v_max_f32 v12, v12, v13
  v_cmp_gt_f32 vcc, v12, v3
  s_cbranch_vccnz L_rare_b0_m
L_back_b0_m:
  v_fma_f32 v14, v8, s38, -v4
  v_fma_f32 v15, v9, s38, -v4
  v_fma_f32 v16, v10, s38, -v4
  v_fma_f32 v17, v11, s38, -v4
  v_exp_f32 v14, v14
  v_exp_f32 v15, v15
  v_exp_f32 v16, v16
  v_exp_f32 v17, v17
  v_add_f32 v18, v14, v15
  v_cvt_pk_bf16_f32 v20, v14, v15
  v_add_f32 v19, v16, v17
  v_cvt_pk_bf16_f32 v21, v16, v17
  v_add_f32 v18, v18, v19
  v_mov_b32 v22, v20
  v_mov_b32 v23, v21
  v_add_f32 v5, v5, v18
  s_nop 0
  v_permlane16_swap_b32 v20, v22
  v_permlane16_swap_b32 v21, v23
  s_waitcnt vmcnt(16)
  v_perm_b32 v24, v76, v72, s39
  v_perm_b32 v25, v84, v80, s39
  v_perm_b32 v26, v76, v72, s40
  v_perm_b32 v27, v84, v80, s40
  v_perm_b32 v28, v77, v73, s39
  v_perm_b32 v29, v85, v81, s39
  v_perm_b32 v30, v77, v73, s40
  v_perm_b32 v31, v85, v81, s40
  v_perm_b32 v32, v78, v74, s39
  v_perm_b32 v33, v86, v82, s39
  v_perm_b32 v34, v78, v74, s40
  v_perm_b32 v35, v86, v82, s40
  v_perm_b32 v36, v79, v75, s39
  v_perm_b32 v37, v87, v83, s39
  v_perm_b32 v38, v79, v75, s40
  v_perm_b32 v39, v87, v83, s40
  v_mfma_f32_4x4x4_16b_bf16 v[40:43], v[20:21], v[24:25], v[40:43]
  v_mfma_f32_4x4x4_16b_bf16 v[44:47], v[20:21], v[26:27], v[44:47]
  v_mfma_f32_4x4x4_16b_bf16 v[48:51], v[20:21], v[28:29], v[48:51]
  v_mfma_f32_4x4x4_16b_bf16 v[52:55], v[20:21], v[30:31], v[52:55]
  v_mfma_f32_4x4x4_16b_bf16 v[56:59], v[20:21], v[32:33], v[56:59]
  v_mfma_f32_4x4x4_16b_bf16 v[60:63], v[20:21], v[34:35], v[60:63]
  v_mfma_f32_4x4x4_16b_bf16 v[64:67], v[20:21], v[36:37], v[64:67]
  v_mfma_f32_4x4x4_16b_bf16 v[68:71], v[20:21], v[38:39], v[68:71]
  v_perm_b32 v24, v92, v88, s39
  v_perm_b32 v25, v100, v96, s39
  v_perm_b32 v26, v92, v88, s40
  v_perm_b32 v27, v100, v96, s40
  v_perm_b32 v28, v93, v89, s39
  v_perm_b32 v29, v101, v97, s39
  v_perm_b32 v30, v93, v89, s40
  v_perm_b32 v31, v101, v97, s40
  v_perm_b32 v32, v94, v90, s39
  v_perm_b32 v33, v102, v98, s39
  v_perm_b32 v34, v94, v90, s40
  v_perm_b32 v35, v102, v98, s40
  v_perm_b32 v36, v95, v91, s39
  v_perm_b32 v37, v103, v99, s39
  v_perm_b32 v38, v95, v91, s40
  v_perm_b32 v39, v103, v99, s40
  v_mfma_f32_4x4x4_16b_bf16 v[40:43], v[22:23], v[24:25], v[40:43]
  v_mfma_f32_4x4x4_16b_bf16 v[44:47], v[22:23], v[26:27], v[44:47]
  v_mfma_f32_4x4x4_16b_bf16 v[48:51], v[22:23], v[28:29], v[48:51]
  v_mfma_f32_4x4x4_16b_bf16 v[52:55], v[22:23], v[30:31], v[52:55]
  v_mfma_f32_4x4x4_16b_bf16 v[56:59], v[22:23], v[32:33], v[56:59]
  v_mfma_f32_4x4x4_16b_bf16 v[60:63], v[22:23], v[34:35], v[60:63]
  v_mfma_f32_4x4x4_16b_bf16 v[64:67], v[22:23], v[36:37], v[64:67]
  v_mfma_f32_4x4x4_16b_bf16 v[68:71], v[22:23], v[38:39], v[68:71]
  s_mov_b32 s41, s32
  s_cmp_eq_u32 s41, s37
  s_mov_b32 s33, 1
  s_cbranch_scc0 L_flush_m
L_body_b1_m:
  s_cmp_eq_u32 s87, 0
  s_cbranch_scc1 L_st_b1_m
  s_mov_b32 s88, 1
  s_atomic_add s88, s[24:25], s89 glc
  s_waitcnt vmcnt(8)
  s_branch L_mf_b1_m
L_st_b1_m:
  s_waitcnt vmcnt(8)
  v_mov_b32 v13, 55568
  v_mov_b32 v14, 1
  s_mov_b64 exec, 1
  ds_add_rtn_u32 v12, v13, v14
  s_mov_b64 exec, -1
L_mf_b1_m:
  v_mfma_f32_16x16x32_bf16 v[8:11], a[32:35], a[64:67], 0
  v_mfma_f32_16x16x32_bf16 v[8:11], a[36:39], a[68:71], v[8:11]
  v_mfma_f32_16x16x32_bf16 v[8:11], a[40:43], a[72:75], v[8:11]
  v_mfma_f32_16x16x32_bf16 v[8:11], a[44:47], a[76:79], v[8:11]
  v_mfma_f32_16x16x32_bf16 v[8:11], a[48:51], a[80:83], v[8:11]
  v_mfma_f32_16x16x32_bf16 v[8:11], a[52:55], a[84:87], v[8:11]
  v_mfma_f32_16x16x32_bf16 v[8:11], a[56:59], a[88:91], v[8:11]
  v_mfma_f32_16x16x32_bf16 v[8:11], a[60:63], a[92:95], v[8:11]
  s_waitcnt lgkmcnt(0)
  s_cmp_eq_u32 s87, 0
  s_cbranch_scc0 L_wd_b1_m
  s_waitcnt lgkmcnt(0)
  v_readfirstlane_b32 s44, v12
  s_nop 0
  s_lshr_b32 s45, s44, 7
  s_min_u32 s45, s45, 2
  s_cmp_eq_u32 s45, s32
  s_cbranch_scc0 L_newph_b1_m
L_phok_b1_m:
  s_cmp_ge_u32 s44, 368
  s_cbranch_scc1 L_dyn_b1_m
  s_and_b32 s44, s44, 127
  s_lshl_b32 s44, s44, 13
  s_add_u32 s30, s44, s31
L_dyn_done_b1_m:
  s_mov_b32 s35, s32
  buffer_load_dwordx4 a[0:3], v1, s[8:11], s30 offen offset:0 nt
  buffer_load_dwordx4 a[4:7], v1, s[8:11], s30 offen offset:64 nt
  buffer_load_dwordx4 a[8:11], v1, s[8:11], s30 offen offset:128 nt
  buffer_load_dwordx4 a[12:15], v1, s[8:11], s30 offen offset:192 nt
  buffer_load_dwordx4 a[16:19], v1, s[8:11], s30 offen offset:256 nt
  buffer_load_dwordx4 a[20:23], v1, s[8:11], s30 offen offset:320 nt
  buffer_load_dwordx4 a[24:27], v1, s[8:11], s30 offen offset:384 nt
  buffer_load_dwordx4 a[28:31], v1, s[8:11], s30 offen offset:448 nt
  buffer_load_dwordx4 v[72:75], v2, s[12:15], s30 offen offset:0 nt
  buffer_load_dwordx4 v[76:79], v2, s[12:15], s30 offen offset:512 nt
  buffer_load_dwordx4 v[80:83], v2, s[12:15], s30 offen offset:1024 nt
  buffer_load_dwordx4 v[84:87], v2, s[12:15], s30 offen offset:1536 nt
  buffer_load_dwordx4 v[88:91], v2, s[12:15], s30 offen offset:2048 nt
  buffer_load_dwordx4 v[92:95], v2, s[12:15], s30 offen offset:2560 nt
  buffer_load_dwordx4 v[96:99], v2, s[12:15], s30 offen offset:3072 nt
  buffer_load_dwordx4 v[100:103], v2, s[12:15], s30 offen offset:3584 nt
  v_max3_f32 v12, v8, v9, v10
  v_max_f32 v12, v12, v11
  v_mov_b32 v13, v12
  s_nop 1
  v_permlane16_swap_b32 v12, v13
  v_max_f32 v12, v12, v13
  v_mov_b32 v13, v12
  s_nop 1
  v_permlane32_swap_b32 v12, v13
  v_max_f32 v12, v12, v13
  v_cmp_gt_f32 vcc, v12, v3
  s_cbranch_vccnz L_rare_b1_m
L_back_b1_m:
  v_fma_f32 v14, v8, s38, -v4
  v_fma_f32 v15, v9, s38, -v4
  v_fma_f32 v16, v10, s38, -v4
  v_fma_f32 v17, v11, s38, -v4
  v_exp_f32 v14, v14
  v_exp_f32 v15, v15
  v_exp_f32 v16, v16
  v_exp_f32 v17, v17
  v_add_f32 v18, v14, v15
  v_cvt_pk_bf16_f32 v20, v14, v15
  v_add_f32 v19, v16, v17
  v_cvt_pk_bf16_f32 v21, v16, v17
  v_add_f32 v18, v18, v19
  v_mov_b32 v22, v20
  v_mov_b32 v23, v21
  v_add_f32 v5, v5, v18
  s_nop 0
  v_permlane16_swap_b32 v20, v22
  v_permlane16_swap_b32 v21, v23
  s_waitcnt vmcnt(16)
  v_perm_b32 v24, v108, v104, s39
  v_perm_b32 v25, v116, v112, s39
  v_perm_b32 v26, v108, v104, s40
  v_perm_b32 v27, v116, v112, s40
  v_perm_b32 v28, v109, v105, s39
  v_perm_b32 v29, v117, v113, s39
  v_perm_b32 v30, v109, v105, s40
  v_perm_b32 v31, v117, v113, s40
  v_perm_b32 v32, v110, v106, s39
  v_perm_b32 v33, v118, v114, s39
  v_perm_b32 v34, v110, v106, s40
  v_perm_b32 v35, v118, v114, s40
  v_perm_b32 v36, v111, v107, s39
  v_perm_b32 v37, v119, v115, s39
  v_perm_b32 v38, v111, v107, s40
  v_perm_b32 v39, v119, v115, s40
  v_mfma_f32_4x4x4_16b_bf16 v[40:43], v[20:21], v[24:25], v[40:43]
  v_mfma_f32_4x4x4_16b_bf16 v[44:47], v[20:21], v[26:27], v[44:47]
  v_mfma_f32_4x4x4_16b_bf16 v[48:51], v[20:21], v[28:29], v[48:51]
  v_mfma_f32_4x4x4_16b_bf16 v[52:55], v[20:21], v[30:31], v[52:55]
  v_mfma_f32_4x4x4_16b_bf16 v[56:59], v[20:21], v[32:33], v[56:59]
  v_mfma_f32_4x4x4_16b_bf16 v[60:63], v[20:21], v[34:35], v[60:63]
  v_mfma_f32_4x4x4_16b_bf16 v[64:67], v[20:21], v[36:37], v[64:67]
  v_mfma_f32_4x4x4_16b_bf16 v[68:71], v[20:21], v[38:39], v[68:71]
  v_perm_b32 v24, v124, v120, s39
  v_perm_b32 v25, v132, v128, s39
  v_perm_b32 v26, v124, v120, s40
  v_perm_b32 v27, v132, v128, s40
  v_perm_b32 v28, v125, v121, s39
  v_perm_b32 v29, v133, v129, s39
  v_perm_b32 v30, v125, v121, s40
  v_perm_b32 v31, v133, v129, s40
  v_perm_b32 v32, v126, v122, s39
  v_perm_b32 v33, v134, v130, s39
  v_perm_b32 v34, v126, v122, s40
  v_perm_b32 v35, v134, v130, s40
  v_perm_b32 v36, v127, v123, s39
  v_perm_b32 v37, v135, v131, s39
  v_perm_b32 v38, v127, v123, s40
  v_perm_b32 v39, v135, v131, s40
  v_mfma_f32_4x4x4_16b_bf16 v[40:43], v[22:23], v[24:25], v[40:43]
  v_mfma_f32_4x4x4_16b_bf16 v[44:47], v[22:23], v[26:27], v[44:47]
  v_mfma_f32_4x4x4_16b_bf16 v[48:51], v[22:23], v[28:29], v[48:51]
  v_mfma_f32_4x4x4_16b_bf16 v[52:55], v[22:23], v[30:31], v[52:55]
  v_mfma_f32_4x4x4_16b_bf16 v[56:59], v[22:23], v[32:33], v[56:59]
  v_mfma_f32_4x4x4_16b_bf16 v[60:63], v[22:23], v[34:35], v[60:63]
  v_mfma_f32_4x4x4_16b_bf16 v[64:67], v[22:23], v[36:37], v[64:67]
  v_mfma_f32_4x4x4_16b_bf16 v[68:71], v[22:23], v[38:39], v[68:71]
  s_mov_b32 s41, s32
  s_cmp_eq_u32 s41, s37
  s_mov_b32 s33, 0
  s_cbranch_scc0 L_flush_m
  s_branch L_body_b0_m
L_rare_s0_m:
  v_max_f32 v13, v12, v3
  v_sub_f32 v14, v3, v13
  v_mul_f32 v14, s38, v14
  v_exp_f32 v14, v14
  v_mov_b32 v3, v13
  v_mul_f32 v4, s38, v13
  v_mul_f32 v5, v5, v14
  s_nop 0
  v_mov_b32_dpp v15, v14 quad_perm:[0,0,2,2] row_mask:0xf bank_mask:0xf
  v_mov_b32_dpp v16, v14 quad_perm:[1,1,3,3] row_mask:0xf bank_mask:0xf
  v_mul_f32 v40, v40, v15
  v_mul_f32 v41, v41, v16
  v_mul_f32 v44, v44, v15
  v_mul_f32 v45, v45, v16
  v_mul_f32 v48, v48, v15
  v_mul_f32 v49, v49, v16
  v_mul_f32 v52, v52, v15
  v_mul_f32 v53, v53, v16
  v_mul_f32 v56, v56, v15
  v_mul_f32 v57, v57, v16
  v_mul_f32 v60, v60, v15
  v_mul_f32 v61, v61, v16
  v_mul_f32 v64, v64, v15
  v_mul_f32 v65, v65, v16
  v_mul_f32 v68, v68, v15
  v_mul_f32 v69, v69, v16
  s_branch L_back_s0_m
L_rare_s1_m:
  v_max_f32 v13, v12, v3
  v_sub_f32 v14, v3, v13
  v_mul_f32 v14, s38, v14
  v_exp_f32 v14, v14
  v_mov_b32 v3, v13
  v_mul_f32 v4, s38, v13
  v_mul_f32 v5, v5, v14
  s_nop 0
  v_mov_b32_dpp v15, v14 quad_perm:[0,0,2,2] row_mask:0xf bank_mask:0xf
  v_mov_b32_dpp v16, v14 quad_perm:[1,1,3,3] row_mask:0xf bank_mask:0xf
  v_mul_f32 v40, v40, v15
  v_mul_f32 v41, v41, v16
  v_mul_f32 v44, v44, v15
  v_mul_f32 v45, v45, v16
  v_mul_f32 v48, v48, v15
  v_mul_f32 v49, v49, v16
  v_mul_f32 v52, v52, v15
  v_mul_f32 v53, v53, v16
  v_mul_f32 v56, v56, v15
  v_mul_f32 v57, v57, v16
  v_mul_f32 v60, v60, v15
  v_mul_f32 v61, v61, v16
  v_mul_f32 v64, v64, v15
  v_mul_f32 v65, v65, v16
  v_mul_f32 v68, v68, v15
  v_mul_f32 v69, v69, v16
  s_branch L_back_s1_m
L_rare_b0_m:
  v_max_f32 v13, v12, v3
  v_sub_f32 v14, v3, v13
  v_mul_f32 v14, s38, v14
  v_exp_f32 v14, v14
  v_mov_b32 v3, v13
  v_mul_f32 v4, s38, v13
  v_mul_f32 v5, v5, v14
  s_nop 0
  v_mov_b32_dpp v15, v14 quad_perm:[0,0,2,2] row_mask:0xf bank_mask:0xf
  v_mov_b32_dpp v16, v14 quad_perm:[1,1,3,3] row_mask:0xf bank_mask:0xf
  v_mul_f32 v40, v40, v15
  v_mul_f32 v41, v41, v16
  v_mul_f32 v44, v44, v15
  v_mul_f32 v45, v45, v16
  v_mul_f32 v48, v48, v15
  v_mul_f32 v49, v49, v16
  v_mul_f32 v52, v52, v15
  v_mul_f32 v53, v53, v16
  v_mul_f32 v56, v56, v15
  v_mul_f32 v57, v57, v16
  v_mul_f32 v60, v60, v15
  v_mul_f32 v61, v61, v16
  v_mul_f32 v64, v64, v15
  v_mul_f32 v65, v65, v16
  v_mul_f32 v68, v68, v15
  v_mul_f32 v69, v69, v16
  s_branch L_back_b0_m
L_rare_b1_m:
  v_max_f32 v13, v12, v3
  v_sub_f32 v14, v3, v13
  v_mul_f32 v14, s38, v14
  v_exp_f32 v14, v14
  v_mov_b32 v3, v13
  v_mul_f32 v4, s38, v13
  v_mul_f32 v5, v5, v14
  s_nop 0
  v_mov_b32_dpp v15, v14 quad_perm:[0,0,2,2] row_mask:0xf bank_mask:0xf
  v_mov_b32_dpp v16, v14 quad_perm:[1,1,3,3] row_mask:0xf bank_mask:0xf
  v_mul_f32 v40, v40, v15
  v_mul_f32 v41, v41, v16
  v_mul_f32 v44, v44, v15
  v_mul_f32 v45, v45, v16
  v_mul_f32 v48, v48, v15
  v_mul_f32 v49, v49, v16
  v_mul_f32 v52, v52, v15
  v_mul_f32 v53, v53, v16
  v_mul_f32 v56, v56, v15
  v_mul_f32 v57, v57, v16
  v_mul_f32 v60, v60, v15
  v_mul_f32 v61, v61, v16
  v_mul_f32 v64, v64, v15
  v_mul_f32 v65, v65, v16
  v_mul_f32 v68, v68, v15
  v_mul_f32 v69, v69, v16
  s_branch L_back_b1_m
L_newph_s0_m:
  s_mov_b32 s32, s45
  s_cmp_eq_u32 s32, 1
  s_cbranch_scc0 L_np2_s0_m
  s_lshl_b32 s46, s4, 1
  s_add_u32 s46, s46, 1
  s_mov_b32 s47, s44
  s_lshl_b32 s44, s46, 23
  s_lshr_b32 s45, s46, 9
  s_add_u32 s8, s20, s44
  s_addc_u32 s9, s21, s45
  s_and_b32 s9, s9, 0xffff
  s_add_u32 s12, s22, s44
  s_addc_u32 s13, s23, s45
  s_and_b32 s13, s13, 0xffff
  s_mov_b32 s10, 0x800000
  s_mov_b32 s14, 0x800000
  s_mov_b32 s11, 0x20000
  s_mov_b32 s15, 0x20000
  s_mov_b32 s44, s47
  s_branch L_phok_s0_m
L_np2_s0_m:
  s_cmp_eq_u32 s32, 2
  s_cbranch_scc0 L_np3_s0_m
  s_mov_b32 s47, s44
  s_lshl_b32 s44, s4, 23
  s_lshr_b32 s45, s4, 9
  s_add_u32 s8, s16, s44
  s_addc_u32 s9, s17, s45
  s_and_b32 s9, s9, 0xffff
  s_add_u32 s12, s18, s44
  s_addc_u32 s13, s19, s45
  s_and_b32 s13, s13, 0xffff
  s_mov_b32 s10, 0x800000
  s_mov_b32 s14, 0x800000
  s_mov_b32 s11, 0x20000
  s_mov_b32 s15, 0x20000
  s_mov_b32 s44, s47
  s_branch L_phok_s0_m
L_np3_s0_m:
  s_mov_b32 s32, 3
  s_mov_b32 s10, 0
  s_mov_b32 s14, 0
  s_branch L_phok_s0_m
L_dyn_s0_m:
  v_mov_b32 v13, 55584
  s_mov_b32 s46, 0
L_fw_cis0_m:
  ds_read_b32 v12, v13
  s_waitcnt lgkmcnt(0)
  v_readfirstlane_b32 s44, v12
  s_nop 0
  s_cmp_eq_u32 s44, 1
  s_cbranch_scc1 L_fwok_cis0_m
  s_add_u32 s46, s46, 1
  s_cmp_gt_u32 s46, 2000000
  s_cbranch_scc1 L_fail_m
  s_branch L_fw_cis0_m
L_fwok_cis0_m:
  s_mov_b32 s87, 1
  s_mov_b32 s88, 1
  s_mov_b32 s93, 1
  s_atomic_add s88, s[24:25], s89 glc
  s_waitcnt lgkmcnt(0)
L_wd_s0_m:
  s_cmp_lt_u32 s88, 32
  s_cbranch_scc0 L_dyn_end_s0_m
  s_mov_b32 s46, s88
  s_lshr_b32 s44, s46, 2
  s_lshl_b32 s44, s44, 7
  s_and_b32 s45, s46, 3
  s_add_u32 s44, s44, s45
  s_mul_i32 s45, s90, 4
  s_add_u32 s44, s44, s45
  s_add_u32 s44, s44, 112
  s_lshl_b32 s30, s44, 13
  s_branch L_dyn_done_s0_m
L_dyn_end_s0_m:
  s_mov_b32 s32, 3
  s_mov_b32 s10, 0
  s_mov_b32 s14, 0
  s_mov_b32 s30, 0
  v_mov_b32 v13, 55588
  v_mov_b32 v12, 1
  s_mov_b64 exec, 1
  ds_add_u32 v13, v12
  s_mov_b64 exec, -1
  s_branch L_dyn_done_s0_m
L_newph_b0_m:
  s_mov_b32 s32, s45
  s_cmp_eq_u32 s32, 1
  s_cbranch_scc0 L_np2_b0_m
  s_lshl_b32 s46, s4, 1
  s_add_u32 s46, s46, 1
  s_mov_b32 s47, s44
  s_lshl_b32 s44, s46, 23
  s_lshr_b32 s45, s46, 9
  s_add_u32 s8, s20, s44
  s_addc_u32 s9, s21, s45
  s_and_b32 s9, s9, 0xffff
  s_add_u32 s12, s22, s44
  s_addc_u32 s13, s23, s45
  s_and_b32 s13, s13, 0xffff
  s_mov_b32 s10, 0x800000
  s_mov_b32 s14, 0x800000
  s_mov_b32 s11, 0x20000
  s_mov_b32 s15, 0x20000
  s_mov_b32 s44, s47
  s_branch L_phok_b0_m
L_np2_b0_m:
  s_cmp_eq_u32 s32, 2
  s_cbranch_scc0 L_np3_b0_m
  s_mov_b32 s47, s44
  s_lshl_b32 s44, s4, 23
  s_lshr_b32 s45, s4, 9
  s_add_u32 s8, s16, s44
  s_addc_u32 s9, s17, s45
  s_and_b32 s9, s9, 0xffff
  s_add_u32 s12, s18, s44
  s_addc_u32 s13, s19, s45
  s_and_b32 s13, s13, 0xffff
  s_mov_b32 s10, 0x800000
  s_mov_b32 s14, 0x800000
  s_mov_b32 s11, 0x20000
  s_mov_b32 s15, 0x20000
  s_mov_b32 s44, s47
  s_branch L_phok_b0_m
L_np3_b0_m:
  s_mov_b32 s32, 3
  s_mov_b32 s10, 0
  s_mov_b32 s14, 0
  s_branch L_phok_b0_m
L_dyn_b0_m:
  v_mov_b32 v13, 55584
  s_mov_b32 s46, 0
L_fw_cib0_m:
  ds_read_b32 v12, v13
  s_waitcnt lgkmcnt(0)
  v_readfirstlane_b32 s44, v12
  s_nop 0
  s_cmp_eq_u32 s44, 1
  s_cbranch_scc1 L_fwok_cib0_m
  s_add_u32 s46, s46, 1
  s_cmp_gt_u32 s46, 2000000
  s_cbranch_scc1 L_fail_m
  s_branch L_fw_cib0_m
L_fwok_cib0_m:
  s_mov_b32 s87, 1
  s_mov_b32 s88, 1
  s_mov_b32 s93, 1
  s_atomic_add s88, s[24:25], s89 glc
  s_waitcnt lgkmcnt(0)
L_wd_b0_m:
  s_cmp_lt_u32 s88, 32
  s_cbranch_scc0 L_dyn_end_b0_m
  s_mov_b32 s46, s88
  s_lshr_b32 s44, s46, 2
  s_lshl_b32 s44, s44, 7
  s_and_b32 s45, s46, 3
  s_add_u32 s44, s44, s45
  s_mul_i32 s45, s90, 4
  s_add_u32 s44, s44, s45
  s_add_u32 s44, s44, 112
  s_lshl_b32 s30, s44, 13
  s_branch L_dyn_done_b0_m
L_dyn_end_b0_m:
  s_mov_b32 s32, 3
  s_mov_b32 s10, 0
  s_mov_b32 s14, 0
  s_mov_b32 s30, 0
  v_mov_b32 v13, 55588
  v_mov_b32 v12, 1
  s_mov_b64 exec, 1
  ds_add_u32 v13, v12
  s_mov_b64 exec, -1
  s_branch L_dyn_done_b0_m
L_newph_b1_m:
  s_mov_b32 s32, s45
  s_cmp_eq_u32 s32, 1
  s_cbranch_scc0 L_np2_b1_m
  s_lshl_b32 s46, s4, 1
  s_add_u32 s46, s46, 1
  s_mov_b32 s47, s44
  s_lshl_b32 s44, s46, 23
  s_lshr_b32 s45, s46, 9
  s_add_u32 s8, s20, s44
  s_addc_u32 s9, s21, s45
  s_and_b32 s9, s9, 0xffff
  s_add_u32 s12, s22, s44
  s_addc_u32 s13, s23, s45
  s_and_b32 s13, s13, 0xffff
  s_mov_b32 s10, 0x800000
  s_mov_b32 s14, 0x800000
  s_mov_b32 s11, 0x20000
  s_mov_b32 s15, 0x20000
  s_mov_b32 s44, s47
  s_branch L_phok_b1_m
L_np2_b1_m:
  s_cmp_eq_u32 s32, 2
  s_cbranch_scc0 L_np3_b1_m
  s_mov_b32 s47, s44
  s_lshl_b32 s44, s4, 23
  s_lshr_b32 s45, s4, 9
  s_add_u32 s8, s16, s44
  s_addc_u32 s9, s17, s45
  s_and_b32 s9, s9, 0xffff
  s_add_u32 s12, s18, s44
  s_addc_u32 s13, s19, s45
  s_and_b32 s13, s13, 0xffff
  s_mov_b32 s10, 0x800000
  s_mov_b32 s14, 0x800000
  s_mov_b32 s11, 0x20000
  s_mov_b32 s15, 0x20000
  s_mov_b32 s44, s47
  s_branch L_phok_b1_m
L_np3_b1_m:
  s_mov_b32 s32, 3
  s_mov_b32 s10, 0
  s_mov_b32 s14, 0
  s_branch L_phok_b1_m
L_dyn_b1_m:
  v_mov_b32 v13, 55584
  s_mov_b32 s46, 0
L_fw_cib1_m:
  ds_read_b32 v12, v13
  s_waitcnt lgkmcnt(0)
  v_readfirstlane_b32 s44, v12
  s_nop 0
  s_cmp_eq_u32 s44, 1
  s_cbranch_scc1 L_fwok_cib1_m
  s_add_u32 s46, s46, 1
  s_cmp_gt_u32 s46, 2000000
  s_cbranch_scc1 L_fail_m
  s_branch L_fw_cib1_m
L_fwok_cib1_m:
  s_mov_b32 s87, 1
  s_mov_b32 s88, 1
  s_mov_b32 s93, 1
  s_atomic_add s88, s[24:25], s89 glc
  s_waitcnt lgkmcnt(0)
L_wd_b1_m:
  s_cmp_lt_u32 s88, 32
  s_cbranch_scc0 L_dyn_end_b1_m
  s_mov_b32 s46, s88
  s_lshr_b32 s44, s46, 2
  s_lshl_b32 s44, s44, 7
  s_and_b32 s45, s46, 3
  s_add_u32 s44, s44, s45
  s_mul_i32 s45, s90, 4
  s_add_u32 s44, s44, s45
  s_add_u32 s44, s44, 112
  s_lshl_b32 s30, s44, 13
  s_branch L_dyn_done_b1_m
L_dyn_end_b1_m:
  s_mov_b32 s32, 3
  s_mov_b32 s10, 0
  s_mov_b32 s14, 0
  s_mov_b32 s30, 0
  v_mov_b32 v13, 55588
  v_mov_b32 v12, 1
  s_mov_b64 exec, 1
  ds_add_u32 v13, v12
  s_mov_b64 exec, -1
  s_branch L_dyn_done_b1_m
L_flush_m:
  s_nop 4
  s_mov_b32 s92, 0
  s_cmp_eq_u32 s37, 2
  s_cbranch_scc0 L_nobpre_m
  s_lshr_b32 s44, s83, 4
  s_add_u32 s44, s44, 16
  s_lshl_b32 s44, s44, 2
  s_add_u32 s44, s44, s3
  s_lshl_b32 s44, s44, 3
  s_lshl_b32 s45, s44, 4
  s_add_u32 s45, s45, 139264
  s_lshl_b32 s46, s44, 10
  s_add_u32 s46, s46, 262144
  s_lshr_b32 s47, s83, 2
  s_and_b32 s47, s47, 3
  s_lshl_b32 s47, s47, 8
  s_add_u32 s46, s46, s47
  v_lshrrev_b32 v12, 4, v6
  v_and_b32 v13, 15, v6
  v_lshlrev_b32 v14, 4, v12
  v_add_u32 v14, s45, v14
  v_lshlrev_b32 v15, 10, v12
  v_lshl_add_u32 v15, v13, 4, v15
  v_add_u32 v15, s46, v15
  v_add_u32 v16, 4096, v15
  s_mov_b32 s48, 0
  s_mov_b32 s49, 0x0c0c0400
  s_mov_b32 s50, 0x04000c0c
  global_load_dwordx4 v[80:83], v14, s[24:25] sc1
  global_load_dwordx4 v[84:87], v14, s[24:25] offset:64 sc1
  global_load_dwordx4 v[72:75], v15, s[24:25] sc1
  global_load_dwordx4 v[76:79], v16, s[24:25] sc1
L_nobpre_m:
  v_permlane32_swap_b32 v40, v41
  v_permlane32_swap_b32 v44, v45
  v_permlane32_swap_b32 v48, v49
  v_permlane32_swap_b32 v52, v53
  v_permlane32_swap_b32 v56, v57
  v_permlane32_swap_b32 v60, v61
  v_permlane32_swap_b32 v64, v65
  v_permlane32_swap_b32 v68, v69
  v_add_f32 v24, v40, v41
  v_add_f32 v25, v44, v45
  v_add_f32 v26, v48, v49
  v_add_f32 v27, v52, v53
  v_add_f32 v28, v56, v57
  v_add_f32 v29, v60, v61
  v_add_f32 v30, v64, v65
  v_add_f32 v31, v68, v69
  v_mov_b32 v12, v5
  s_nop 1
  v_permlane16_swap_b32 v5, v12
  v_add_f32 v5, v5, v12
  v_mov_b32 v12, v5
  s_nop 1
  v_permlane32_swap_b32 v5, v12
  v_add_f32 v5, v5, v12
  s_lshl_b32 s44, s37, 13
  s_lshl_b32 s45, s3, 11
  s_add_u32 s44, s44, s45
  s_add_u32 s44, s44, 30720
  v_lshlrev_b32 v12, 5, v6
  v_add_u32 v12, s44, v12
  ds_write_b128 v12, v[24:27]
  ds_write_b128 v12, v[28:31] offset:16
  s_lshl_b32 s44, s37, 6
  s_lshl_b32 s45, s3, 4
  s_add_u32 s44, s44, s45
  s_add_u32 s44, s44, 55296
  v_and_b32 v13, 1, v6
  v_lshlrev_b32 v13, 3, v13
  v_add_u32 v13, s44, v13
  v_mov_b32 v14, v4
  v_mov_b32 v15, v5
  ds_write_b64 v13, v[14:15]
  s_waitcnt lgkmcnt(0)
  s_lshl_b32 s44, s37, 2
  s_add_u32 s44, s44, 55552
  v_mov_b32 v12, s44
  v_mov_b32 v13, 1
  s_mov_b64 exec, 1
  ds_add_rtn_u32 v14, v12, v13
  s_mov_b64 exec, -1
  s_waitcnt lgkmcnt(0)
  v_readfirstlane_b32 s44, v14
  s_nop 0
  s_cmp_eq_u32 s44, 3
  s_cbranch_scc0 L_nomerge_m
  s_lshl_b32 s44, s37, 6
  s_add_u32 s44, s44, 55296
  v_mov_b32 v20, s44
  s_lshl_b32 s44, s37, 13
  s_add_u32 s44, s44, 30720
  v_lshlrev_b32 v21, 4, v6
  v_add_u32 v22, s44, v21
  ds_read_b128 v[24:27], v20 offset:0
  ds_read_b128 v[28:31], v20 offset:16
  ds_read_b128 v[32:35], v20 offset:32
  ds_read_b128 v[36:39], v20 offset:48
  ds_read_b128 v[40:43], v22 offset:0
  ds_read_b128 v[44:47], v22 offset:2048
  ds_read_b128 v[48:51], v22 offset:4096
  ds_read_b128 v[52:55], v22 offset:6144
  ds_read_b128 v[56:59], v22 offset:1024
  ds_read_b128 v[60:63], v22 offset:3072
  ds_read_b128 v[64:67], v22 offset:5120
  ds_read_b128 v[68:71], v22 offset:7168
  s_and_b32 s46, s4, 7
  s_lshl_b32 s46, s46, 1
  s_lshr_b32 s47, s4, 3
  s_cmp_eq_u32 s37, 2
  s_cselect_b32 s48, 0, 16
  s_cselect_b32 s49, 0, s37
  s_add_u32 s46, s46, s48
  s_add_u32 s46, s46, s49
  s_lshl_b32 s46, s46, 2
  s_add_u32 s46, s46, s47
  s_lshl_b32 s46, s46, 3
  s_add_u32 s46, s46, s5
  s_lshl_b32 s44, s46, 10
  s_add_u32 s44, s44, 262144
  v_add_u32 v21, s44, v21
  s_lshl_b32 s44, s46, 4
  s_add_u32 s44, s44, 139264
  v_mov_b32 v23, s44
  v_mov_b32 v7, s7
  s_waitcnt lgkmcnt(8)
  v_max3_f32 v16, v24, v28, v32
  v_max3_f32 v17, v26, v30, v34
  v_max_f32 v16, v16, v36
  v_max_f32 v17, v17, v38
  v_sub_f32 v24, v24, v16
  v_sub_f32 v26, v26, v17
  v_sub_f32 v28, v28, v16
  v_sub_f32 v30, v30, v17
  v_sub_f32 v32, v32, v16
  v_sub_f32 v34, v34, v17
  v_sub_f32 v36, v36, v16
  v_sub_f32 v38, v38, v17
  v_exp_f32 v24, v24
  v_exp_f32 v26, v26
  v_exp_f32 v28, v28
  v_exp_f32 v30, v30
  v_exp_f32 v32, v32
  v_exp_f32 v34, v34
  v_exp_f32 v36, v36
  v_exp_f32 v38, v38
  s_nop 0
  v_mul_f32 v18, v24, v25
  v_mul_f32 v19, v26, v27
  v_fmac_f32 v18, v28, v29
  v_fmac_f32 v19, v30, v31
  v_fmac_f32 v18, v32, v33
  v_fmac_f32 v19, v34, v35
  v_fmac_f32 v18, v36, v37
  v_fmac_f32 v19, v38, v39
  s_waitcnt lgkmcnt(4)
  v_mul_f32 v8, v24, v40
  v_mul_f32 v9, v24, v41
  v_mul_f32 v10, v24, v42
  v_mul_f32 v11, v24, v43
  v_fmac_f32 v8, v28, v44
  v_fmac_f32 v9, v28, v45
  v_fmac_f32 v10, v28, v46
  v_fmac_f32 v11, v28, v47
  v_fmac_f32 v8, v32, v48
  v_fmac_f32 v9, v32, v49
  v_fmac_f32 v10, v32, v50
  v_fmac_f32 v11, v32, v51
  v_fmac_f32 v8, v36, v52
  v_fmac_f32 v9, v36, v53
  v_fmac_f32 v10, v36, v54
  v_fmac_f32 v11, v36, v55
  s_mov_b32 s44, 0x7060500
  v_perm_b32 v8, v8, v7, s44
  s_mov_b32 s44, 0x7060501
  v_perm_b32 v9, v9, v7, s44
  s_mov_b32 s44, 0x7060502
  v_perm_b32 v10, v10, v7, s44
  s_mov_b32 s44, 0x7060503
  v_perm_b32 v11, v11, v7, s44
  global_store_dwordx4 v21, v[8:11], s[24:25] sc1
  s_mov_b32 s92, 4
  s_cmp_eq_u32 s37, 2
  s_cbranch_scc0 L_m_one_m
  s_waitcnt lgkmcnt(0)
  v_mul_f32 v12, v26, v56
  v_mul_f32 v13, v26, v57
  v_mul_f32 v14, v26, v58
  v_mul_f32 v15, v26, v59
  v_fmac_f32 v12, v30, v60
  v_fmac_f32 v13, v30, v61
  v_fmac_f32 v14, v30, v62
  v_fmac_f32 v15, v30, v63
  v_fmac_f32 v12, v34, v64
  v_fmac_f32 v13, v34, v65
  v_fmac_f32 v14, v34, v66
  v_fmac_f32 v15, v34, v67
  v_fmac_f32 v12, v38, v68
  v_fmac_f32 v13, v38, v69
  v_fmac_f32 v14, v38, v70
  v_fmac_f32 v15, v38, v71
  s_mov_b32 s44, 0x7060500
  v_perm_b32 v12, v12, v7, s44
  s_mov_b32 s44, 0x7060501
  v_perm_b32 v13, v13, v7, s44
  s_mov_b32 s44, 0x7060502
  v_perm_b32 v14, v14, v7, s44
  s_mov_b32 s44, 0x7060503
  v_perm_b32 v15, v15, v7, s44
  v_add_u32 v21, 32768, v21
  global_store_dwordx4 v21, v[12:15], s[24:25] sc1
  v_mov_b32 v44, v17
  v_mov_b32 v45, s6
  v_mov_b32 v46, v19
  v_mov_b32 v47, s6
  s_mov_b64 exec, 1
  global_store_dwordx4 v23, v[44:47], s[24:25] offset:512 sc1
  s_mov_b64 exec, -1
L_m_one_m:
  v_mov_b32 v40, v16
  v_mov_b32 v41, s6
  v_mov_b32 v42, v18
  v_mov_b32 v43, s6
  s_mov_b64 exec, 1
  global_store_dwordx4 v23, v[40:43], s[24:25] sc1
  s_mov_b64 exec, -1
  s_waitcnt lgkmcnt(0)
L_nomerge_m:
  s_add_u32 s37, s37, 1
  s_cmp_eq_u32 s37, 3
  s_cbranch_scc1 L_tail_m
  s_nop 0
  v_mov_b32 v3, 0xff800000
  v_mov_b32 v4, 0xff800000
  v_mov_b32 v5, 0
  v_mov_b32 v40, 0
  v_mov_b32 v41, 0
  v_mov_b32 v42, 0
  v_mov_b32 v43, 0
  v_mov_b32 v44, 0
  v_mov_b32 v45, 0
  v_mov_b32 v46, 0
  v_mov_b32 v47, 0
  v_mov_b32 v48, 0
  v_mov_b32 v49, 0
  v_mov_b32 v50, 0
  v_mov_b32 v51, 0
  v_mov_b32 v52, 0
  v_mov_b32 v53, 0
  v_mov_b32 v54, 0
  v_mov_b32 v55, 0
  v_mov_b32 v56, 0
  v_mov_b32 v57, 0
  v_mov_b32 v58, 0
  v_mov_b32 v59, 0
  v_mov_b32 v60, 0
  v_mov_b32 v61, 0
  v_mov_b32 v62, 0
  v_mov_b32 v63, 0
  v_mov_b32 v64, 0
  v_mov_b32 v65, 0
  v_mov_b32 v66, 0
  v_mov_b32 v67, 0
  v_mov_b32 v68, 0
  v_mov_b32 v69, 0
  v_mov_b32 v70, 0
  v_mov_b32 v71, 0
  s_cmp_lt_u32 s37, s41
  s_cbranch_scc1 L_flush_m
  v_mov_b32 v13, 55572
  s_mov_b32 s46, 0
L_fw_qf_m:
  ds_read_b32 v12, v13
  s_waitcnt lgkmcnt(0)
  v_readfirstlane_b32 s44, v12
  s_nop 0
  s_cmp_eq_u32 s44, 1
  s_cbranch_scc1 L_fwok_qf_m
  s_add_u32 s46, s46, 1
  s_cmp_gt_u32 s46, 2000000
  s_cbranch_scc1 L_fail_m
  s_branch L_fw_qf_m
L_fwok_qf_m:
  v_and_b32 v12, 1, v6
  s_cmp_eq_u32 s37, 2
  s_cselect_b32 s44, 512, 0
  v_mul_u32_u24 v12, s44, v12
  s_lshl_b32 s44, s37, 9
  s_add_u32 s44, s44, 28672
  v_add_u32 v12, s44, v12
  v_lshrrev_b32 v13, 4, v6
  v_lshl_add_u32 v12, v13, 4, v12
  ds_read_b128 a[64:67], v12 offset:0
  ds_read_b128 a[68:71], v12 offset:64
  ds_read_b128 a[72:75], v12 offset:128
  ds_read_b128 a[76:79], v12 offset:192
  ds_read_b128 a[80:83], v12 offset:256
  ds_read_b128 a[84:87], v12 offset:320
  ds_read_b128 a[88:91], v12 offset:384
  ds_read_b128 a[92:95], v12 offset:448
  s_waitcnt lgkmcnt(0)
  s_cmp_eq_u32 s33, 0
  s_cbranch_scc1 L_body_b0_m
  s_branch L_body_b1_m
L_tail_m:
  s_cmp_eq_u32 s92, 4
  s_cbranch_scc1 L_tw4_m
  s_waitcnt vmcnt(0)
  s_branch L_tw_m
L_tw4_m:
  s_waitcnt vmcnt(4)
L_tw_m:
  s_lshr_b32 s44, s83, 4
  s_add_u32 s44, s44, 16
  s_lshl_b32 s44, s44, 2
  s_add_u32 s44, s44, s3
  s_lshl_b32 s44, s44, 3
  s_lshl_b32 s45, s44, 4
  s_add_u32 s45, s45, 139264
  s_lshl_b32 s46, s44, 10
  s_add_u32 s46, s46, 262144
  s_lshr_b32 s47, s83, 2
  s_and_b32 s47, s47, 3
  s_lshl_b32 s47, s47, 8
  s_add_u32 s46, s46, s47
  v_lshrrev_b32 v12, 4, v6
  v_and_b32 v13, 15, v6
  v_lshlrev_b32 v14, 4, v12
  v_add_u32 v14, s45, v14
  v_lshlrev_b32 v15, 10, v12
  v_lshl_add_u32 v15, v13, 4, v15
  v_add_u32 v15, s46, v15
  v_add_u32 v16, 4096, v15
  s_mov_b32 s48, 0
  s_mov_b32 s49, 0x0c0c0400
  s_mov_b32 s50, 0x04000c0c
  v_mov_b32 v24, v72
  v_mov_b32 v25, v73
  v_mov_b32 v26, v74
  v_mov_b32 v27, v75
  v_mov_b32 v28, v76
  v_mov_b32 v29, v77
  v_mov_b32 v30, v78
  v_mov_b32 v31, v79
  v_mov_b32 v32, v80
  v_mov_b32 v33, v81
  v_mov_b32 v34, v82
  v_mov_b32 v35, v83
  v_mov_b32 v36, v84
  v_mov_b32 v37, v85
  v_mov_b32 v38, v86
  v_mov_b32 v39, v87
  s_branch L_role_chk_B_m
L_role_poll_B_m:
  global_load_dwordx4 v[32:35], v14, s[24:25] sc1
  global_load_dwordx4 v[36:39], v14, s[24:25] offset:64 sc1
  global_load_dwordx4 v[24:27], v15, s[24:25] sc1
  global_load_dwordx4 v[28:31], v16, s[24:25] sc1
  s_waitcnt vmcnt(0)
L_role_chk_B_m:
  v_perm_b32 v17, v25, v24, s49
  v_perm_b32 v18, v27, v26, s50
  v_or_b32 v17, v17, v18
  v_perm_b32 v18, v29, v28, s49
  v_perm_b32 v19, v31, v30, s50
  v_or_b32 v18, v18, v19
  v_xor_b32 v17, s7, v17
  v_xor_b32 v18, s7, v18
  v_or_b32 v17, v17, v18
  v_xor_b32 v18, s6, v33
  v_xor_b32 v19, s6, v37
  v_or3_b32 v17, v17, v18, v19
  v_xor_b32 v18, s6, v35
  v_xor_b32 v19, s6, v39
  v_or3_b32 v17, v17, v18, v19
  v_cmp_ne_u32 vcc, 0, v17
  s_cbranch_vccz L_role_ok_B_m
  s_add_u32 s48, s48, 1
  s_cmp_gt_u32 s48, 200000
  s_cbranch_scc1 L_fail_m
  s_sleep 1
  s_branch L_role_poll_B_m
L_role_ok_B_m:
  v_max_f32 v17, v32, v36
  v_mov_b32 v18, v17
  s_nop 1
  v_permlane16_swap_b32 v17, v18
  v_max_f32 v17, v17, v18
  v_mov_b32 v18, v17
  s_nop 1
  v_permlane32_swap_b32 v17, v18
  v_max_f32 v17, v17, v18
  v_sub_f32 v32, v32, v17
  v_sub_f32 v36, v36, v17
  v_exp_f32 v32, v32
  v_exp_f32 v36, v36
  s_nop 0
  v_mul_f32 v17, v32, v34
  v_fmac_f32 v17, v36, v38
  v_mul_f32 v24, v32, v24
  v_fmac_f32 v24, v36, v28
  v_mul_f32 v25, v32, v25
  v_fmac_f32 v25, v36, v29
  v_mul_f32 v26, v32, v26
  v_fmac_f32 v26, v36, v30
  v_mul_f32 v27, v32, v27
  v_fmac_f32 v27, v36, v31
  v_mov_b32 v28, v24
  v_mov_b32 v29, v25
  v_mov_b32 v30, v26
  v_mov_b32 v31, v27
  v_mov_b32 v18, v17
  s_nop 1
  v_permlane16_swap_b32 v24, v28
  v_permlane16_swap_b32 v25, v29
  v_permlane16_swap_b32 v26, v30
  v_permlane16_swap_b32 v27, v31
  v_permlane16_swap_b32 v17, v18
  v_add_f32 v24, v24, v28
  v_add_f32 v25, v25, v29
  v_add_f32 v26, v26, v30
  v_add_f32 v27, v27, v31
  v_add_f32 v17, v17, v18
  v_mov_b32 v28, v24
  v_mov_b32 v29, v25
  v_mov_b32 v30, v26
  v_mov_b32 v31, v27
  v_mov_b32 v18, v17
  s_nop 1
  v_permlane32_swap_b32 v24, v28
  v_permlane32_swap_b32 v25, v29
  v_permlane32_swap_b32 v26, v30
  v_permlane32_swap_b32 v27, v31
  v_permlane32_swap_b32 v17, v18
  v_add_f32 v24, v24, v28
  v_add_f32 v25, v25, v29
  v_add_f32 v26, v26, v30
  v_add_f32 v27, v27, v31
  v_add_f32 v17, v17, v18
  v_rcp_f32 v17, v17
  s_nop 0
  v_mul_f32 v24, v24, v17
  v_mul_f32 v25, v25, v17
  v_mul_f32 v26, v26, v17
  v_mul_f32 v27, v27, v17
  v_cvt_pk_bf16_f32 v24, v24, v25
  v_cvt_pk_bf16_f32 v25, v26, v27
  s_lshl_b32 s44, s3, 7
  s_add_u32 s44, s44, 56832
  v_lshlrev_b32 v13, 3, v13
  v_add_u32 v13, s44, v13
  ds_write_b64 v13, v[24:25]
  s_waitcnt lgkmcnt(0)
  s_barrier
  v_lshrrev_b32 v12, 4, v6
  v_and_b32 v13, 3, v6
  v_lshlrev_b32 v14, 7, v13
  v_lshl_add_u32 v14, v12, 4, v14
  v_add_u32 v14, 56832, v14
  ds_read_b128 v[40:43], v14
  ds_read_b128 v[44:47], v14 offset:64
  v_lshrrev_b32 v15, 2, v6
  v_and_b32 v15, 3, v15
  v_lshl_add_u32 v15, v12, 3, v15
  v_mul_u32_u24 v15, 224, v15
  v_lshl_add_u32 v15, v13, 3, v15
  s_lshl_b32 s44, s3, 6
  s_add_u32 s44, s44, 14336
  v_add_u32 v15, s44, v15
  ds_read_b64_tr_b16 v[48:49], v15 offset:0
  ds_read_b64_tr_b16 v[50:51], v15 offset:896
  ds_read_b64_tr_b16 v[52:53], v15 offset:7168
  ds_read_b64_tr_b16 v[54:55], v15 offset:8064
  ds_read_b64_tr_b16 v[56:57], v15 offset:32
  ds_read_b64_tr_b16 v[58:59], v15 offset:928
  ds_read_b64_tr_b16 v[60:61], v15 offset:7200
  ds_read_b64_tr_b16 v[62:63], v15 offset:8096
  s_waitcnt lgkmcnt(0)
  v_mfma_f32_16x16x32_bf16 v[64:67], v[40:43], v[48:51], 0
  v_mfma_f32_16x16x32_bf16 v[68:71], v[40:43], v[56:59], 0
  v_mfma_f32_16x16x32_bf16 v[64:67], v[44:47], v[52:55], v[64:67]
  v_mfma_f32_16x16x32_bf16 v[68:71], v[44:47], v[60:63], v[68:71]
  v_and_b32 v16, 1, v12
  v_cmp_eq_u32 vcc, 1, v16
  s_nop 6
  v_cndmask_b32 v64, v64, v68, vcc
  v_cndmask_b32 v65, v65, v69, vcc
  v_cndmask_b32 v66, v66, v70, vcc
  v_cndmask_b32 v67, v67, v71, vcc
  v_mov_b32 v7, s7
  s_mov_b32 s44, 0x7060500
  v_perm_b32 v64, v64, v7, s44
  s_mov_b32 s44, 0x7060501
  v_perm_b32 v65, v65, v7, s44
  s_mov_b32 s44, 0x7060502
  v_perm_b32 v66, v66, v7, s44
  s_mov_b32 s44, 0x7060503
  v_perm_b32 v67, v67, v7, s44
  s_and_b32 s44, s83, 3
  s_add_u32 s44, s44, 4
  s_lshl_b32 s44, s44, 6
  s_lshr_b32 s45, s83, 2
  s_add_u32 s44, s44, s45
  s_mul_i32 s44, s44, 1792
  s_lshl_b32 s45, s3, 9
  s_add_u32 s44, s44, s45
  s_add_u32 s44, s44, 1310720
  v_and_b32 v17, 15, v6
  v_lshlrev_b32 v17, 4, v17
  v_lshl_add_u32 v17, v16, 8, v17
  v_add_u32 v17, s44, v17
  s_cmp_eq_u32 s3, 3
  s_cselect_b32 s46, 0xffff, -1
  s_mov_b32 s47, 0
  s_mov_b64 exec, s[46:47]
  global_store_dwordx4 v17, v[64:67], s[24:25] sc1
  s_mov_b64 exec, -1
  s_lshr_b32 s44, s83, 4
  s_add_u32 s44, s44, 0
  s_lshl_b32 s44, s44, 2
  s_add_u32 s44, s44, s3
  s_lshl_b32 s44, s44, 3
  s_lshl_b32 s45, s44, 4
  s_add_u32 s45, s45, 139264
  s_lshl_b32 s46, s44, 10
  s_add_u32 s46, s46, 262144
  s_lshr_b32 s47, s83, 2
  s_and_b32 s47, s47, 3
  s_lshl_b32 s47, s47, 8
  s_add_u32 s46, s46, s47
  v_lshrrev_b32 v12, 4, v6
  v_and_b32 v13, 15, v6
  v_lshlrev_b32 v14, 4, v12
  v_add_u32 v14, s45, v14
  v_lshlrev_b32 v15, 10, v12
  v_lshl_add_u32 v15, v13, 4, v15
  v_add_u32 v15, s46, v15
  v_add_u32 v16, 4096, v15
  s_mov_b32 s48, 0
  s_mov_b32 s49, 0x0c0c0400
  s_mov_b32 s50, 0x04000c0c
L_role_poll_A_m:
  global_load_dwordx4 v[32:35], v14, s[24:25] sc1
  global_load_dwordx4 v[36:39], v14, s[24:25] offset:64 sc1
  global_load_dwordx4 v[24:27], v15, s[24:25] sc1
  global_load_dwordx4 v[28:31], v16, s[24:25] sc1
  s_waitcnt vmcnt(0)
L_role_chk_A_m:
  v_perm_b32 v17, v25, v24, s49
  v_perm_b32 v18, v27, v26, s50
  v_or_b32 v17, v17, v18
  v_perm_b32 v18, v29, v28, s49
  v_perm_b32 v19, v31, v30, s50
  v_or_b32 v18, v18, v19
  v_xor_b32 v17, s7, v17
  v_xor_b32 v18, s7, v18
  v_or_b32 v17, v17, v18
  v_xor_b32 v18, s6, v33
  v_xor_b32 v19, s6, v37
  v_or3_b32 v17, v17, v18, v19
  v_xor_b32 v18, s6, v35
  v_xor_b32 v19, s6, v39
  v_or3_b32 v17, v17, v18, v19
  v_cmp_ne_u32 vcc, 0, v17
  s_cbranch_vccz L_role_ok_A_m
  s_add_u32 s48, s48, 1
  s_cmp_gt_u32 s48, 200000
  s_cbranch_scc1 L_fail_m
  s_sleep 1
  s_branch L_role_poll_A_m
L_role_ok_A_m:
  v_max_f32 v17, v32, v36
  v_mov_b32 v18, v17
  s_nop 1
  v_permlane16_swap_b32 v17, v18
  v_max_f32 v17, v17, v18
  v_mov_b32 v18, v17
  s_nop 1
  v_permlane32_swap_b32 v17, v18
  v_max_f32 v17, v17, v18
  v_sub_f32 v32, v32, v17
  v_sub_f32 v36, v36, v17
  v_exp_f32 v32, v32
  v_exp_f32 v36, v36
  s_nop 0
  v_mul_f32 v17, v32, v34
  v_fmac_f32 v17, v36, v38
  v_mul_f32 v24, v32, v24
  v_fmac_f32 v24, v36, v28
  v_mul_f32 v25, v32, v25
  v_fmac_f32 v25, v36, v29
  v_mul_f32 v26, v32, v26
  v_fmac_f32 v26, v36, v30
  v_mul_f32 v27, v32, v27
  v_fmac_f32 v27, v36, v31
  v_mov_b32 v28, v24
  v_mov_b32 v29, v25
  v_mov_b32 v30, v26
  v_mov_b32 v31, v27
  v_mov_b32 v18, v17
  s_nop 1
  v_permlane16_swap_b32 v24, v28
  v_permlane16_swap_b32 v25, v29
  v_permlane16_swap_b32 v26, v30
  v_permlane16_swap_b32 v27, v31
  v_permlane16_swap_b32 v17, v18
  v_add_f32 v24, v24, v28
  v_add_f32 v25, v25, v29
  v_add_f32 v26, v26, v30
  v_add_f32 v27, v27, v31
  v_add_f32 v17, v17, v18
  v_mov_b32 v28, v24
  v_mov_b32 v29, v25
  v_mov_b32 v30, v26
  v_mov_b32 v31, v27
  v_mov_b32 v18, v17
  s_nop 1
  v_permlane32_swap_b32 v24, v28
  v_permlane32_swap_b32 v25, v29
  v_permlane32_swap_b32 v26, v30
  v_permlane32_swap_b32 v27, v31
  v_permlane32_swap_b32 v17, v18
  v_add_f32 v24, v24, v28
  v_add_f32 v25, v25, v29
  v_add_f32 v26, v26, v30
  v_add_f32 v27, v27, v31
  v_add_f32 v17, v17, v18
  v_rcp_f32 v17, v17
  s_nop 0
  v_mul_f32 v24, v24, v17
  v_mul_f32 v25, v25, v17
  v_mul_f32 v26, v26, v17
  v_mul_f32 v27, v27, v17
  v_cvt_pk_bf16_f32 v24, v24, v25
  v_cvt_pk_bf16_f32 v25, v26, v27
  s_lshl_b32 s44, s3, 7
  s_add_u32 s44, s44, 56320
  v_lshlrev_b32 v13, 3, v13
  v_add_u32 v13, s44, v13
  ds_write_b64 v13, v[24:25]
  s_waitcnt lgkmcnt(0)
  s_barrier
  v_lshrrev_b32 v12, 4, v6
  v_and_b32 v13, 3, v6
  v_lshlrev_b32 v14, 7, v13
  v_lshl_add_u32 v14, v12, 4, v14
  v_add_u32 v14, 56320, v14
  ds_read_b128 v[40:43], v14
  ds_read_b128 v[44:47], v14 offset:64
  v_lshrrev_b32 v15, 2, v6
  v_and_b32 v15, 3, v15
  v_lshl_add_u32 v15, v12, 3, v15
  v_mul_u32_u24 v15, 224, v15
  v_lshl_add_u32 v15, v13, 3, v15
  s_lshl_b32 s44, s3, 6
  s_add_u32 s44, s44, 0
  v_add_u32 v15, s44, v15
  ds_read_b64_tr_b16 v[48:49], v15 offset:0
  ds_read_b64_tr_b16 v[50:51], v15 offset:896
  ds_read_b64_tr_b16 v[52:53], v15 offset:7168
  ds_read_b64_tr_b16 v[54:55], v15 offset:8064
  ds_read_b64_tr_b16 v[56:57], v15 offset:32
  ds_read_b64_tr_b16 v[58:59], v15 offset:928
  ds_read_b64_tr_b16 v[60:61], v15 offset:7200
  ds_read_b64_tr_b16 v[62:63], v15 offset:8096
  s_waitcnt lgkmcnt(0)
  v_mfma_f32_16x16x32_bf16 v[64:67], v[40:43], v[48:51], 0
  v_mfma_f32_16x16x32_bf16 v[68:71], v[40:43], v[56:59], 0
  v_mfma_f32_16x16x32_bf16 v[64:67], v[44:47], v[52:55], v[64:67]
  v_mfma_f32_16x16x32_bf16 v[68:71], v[44:47], v[60:63], v[68:71]
  v_and_b32 v16, 1, v12
  v_cmp_eq_u32 vcc, 1, v16
  s_nop 6
  v_cndmask_b32 v64, v64, v68, vcc
  v_cndmask_b32 v65, v65, v69, vcc
  v_cndmask_b32 v66, v66, v70, vcc
  v_cndmask_b32 v67, v67, v71, vcc
  v_mov_b32 v7, s7
  s_mov_b32 s44, 0x7060500
  v_perm_b32 v64, v64, v7, s44
  s_mov_b32 s44, 0x7060501
  v_perm_b32 v65, v65, v7, s44
  s_mov_b32 s44, 0x7060502
  v_perm_b32 v66, v66, v7, s44
  s_mov_b32 s44, 0x7060503
  v_perm_b32 v67, v67, v7, s44
  s_and_b32 s44, s83, 3
  s_add_u32 s44, s44, 0
  s_lshl_b32 s44, s44, 6
  s_lshr_b32 s45, s83, 2
  s_add_u32 s44, s44, s45
  s_mul_i32 s44, s44, 1792
  s_lshl_b32 s45, s3, 9
  s_add_u32 s44, s44, s45
  s_add_u32 s44, s44, 1310720
  v_and_b32 v17, 15, v6
  v_lshlrev_b32 v17, 4, v17
  v_lshl_add_u32 v17, v16, 8, v17
  v_add_u32 v17, s44, v17
  s_cmp_eq_u32 s3, 3
  s_cselect_b32 s46, 0xffff, -1
  s_mov_b32 s47, 0
  s_mov_b64 exec, s[46:47]
  global_store_dwordx4 v17, v[64:67], s[24:25] sc1
  s_mov_b64 exec, -1
  s_cmp_ge_u32 s2, 224
  s_cbranch_scc1 L_done_m
  s_cmp_ge_u32 s2, 112
  s_cselect_b32 s44, 1, 0
  s_mul_i32 s45, s44, 112
  s_sub_u32 s45, s2, s45
  s_mul_i32 s46, s45, 2341
  s_lshr_b32 s46, s46, 16
  s_mul_i32 s47, s46, 28
  s_sub_u32 s47, s45, s47
  s_lshl_b32 s47, s47, 2
  s_lshl_b32 s48, s44, 2
  s_add_u32 s48, s48, s46
  s_lshl_b32 s48, s48, 6
  s_lshl_b32 s49, s3, 4
  s_add_u32 s48, s48, s49
  s_mul_i32 s48, s48, 1792
  s_lshl_b32 s49, s47, 4
  s_add_u32 s48, s48, s49
  s_add_u32 s48, s48, 1310720
  v_lshrrev_b32 v12, 2, v6
  v_mul_u32_u24 v12, 1792, v12
  v_and_b32 v13, 3, v6
  v_lshl_add_u32 v12, v13, 4, v12
  v_add_u32 v12, s48, v12
  s_mov_b32 s51, 0
  s_mov_b32 s49, 0x0c0c0400
  s_mov_b32 s50, 0x04000c0c
L_fin_poll_f_m:
  global_load_dwordx4 v[24:27], v12, s[24:25] sc1
  s_waitcnt vmcnt(0)
  v_perm_b32 v14, v25, v24, s49
  v_perm_b32 v15, v27, v26, s50
  v_or_b32 v14, v14, v15
  v_cmp_ne_u32 vcc, s7, v14
  s_cbranch_vccz L_fin_ok_f_m
  s_add_u32 s51, s51, 1
  s_cmp_gt_u32 s51, 200000
  s_cbranch_scc1 L_fail_m
  s_sleep 1
  s_branch L_fin_poll_f_m
L_fin_ok_f_m:
  v_add_f32_dpp v28, v24, v24 row_ror:4 row_mask:0xf bank_mask:0xf
  v_add_f32_dpp v29, v25, v25 row_ror:4 row_mask:0xf bank_mask:0xf
  v_add_f32_dpp v30, v26, v26 row_ror:4 row_mask:0xf bank_mask:0xf
  v_add_f32_dpp v31, v27, v27 row_ror:4 row_mask:0xf bank_mask:0xf
  v_mov_b32 v24, v28
  v_mov_b32 v25, v29
  v_mov_b32 v26, v30
  v_mov_b32 v27, v31
  s_nop 1
  v_add_f32_dpp v28, v24, v24 row_ror:8 row_mask:0xf bank_mask:0xf
  v_add_f32_dpp v29, v25, v25 row_ror:8 row_mask:0xf bank_mask:0xf
  v_add_f32_dpp v30, v26, v26 row_ror:8 row_mask:0xf bank_mask:0xf
  v_add_f32_dpp v31, v27, v27 row_ror:8 row_mask:0xf bank_mask:0xf
  v_mov_b32 v24, v28
  v_mov_b32 v25, v29
  v_mov_b32 v26, v30
  v_mov_b32 v27, v31
  s_nop 1
  v_mov_b32 v28, v24
  v_mov_b32 v29, v25
  v_mov_b32 v30, v26
  v_mov_b32 v31, v27
  s_nop 1
  v_permlane16_swap_b32 v24, v28
  v_permlane16_swap_b32 v25, v29
  v_permlane16_swap_b32 v26, v30
  v_permlane16_swap_b32 v27, v31
  v_add_f32 v24, v24, v28
  v_add_f32 v25, v25, v29
  v_add_f32 v26, v26, v30
  v_add_f32 v27, v27, v31
  v_mov_b32 v28, v24
  v_mov_b32 v29, v25
  v_mov_b32 v30, v26
  v_mov_b32 v31, v27
  s_nop 1
  v_permlane32_swap_b32 v24, v28
  v_permlane32_swap_b32 v25, v29
  v_permlane32_swap_b32 v26, v30
  v_permlane32_swap_b32 v27, v31
  v_add_f32 v24, v24, v28
  v_add_f32 v25, v25, v29
  v_add_f32 v26, v26, v30
  v_add_f32 v27, v27, v31
  s_lshl_b32 s48, s3, 6
  s_add_u32 s48, s48, 57344
  v_lshlrev_b32 v14, 4, v13
  v_add_u32 v14, s48, v14
  ds_write_b128 v14, v[24:27]
  s_waitcnt lgkmcnt(0)
  s_barrier
  s_cmp_eq_u32 s3, 0
  s_cbranch_scc0 L_done_m
  v_lshrrev_b32 v15, 2, v6
  v_and_b32 v15, 3, v15
  v_lshlrev_b32 v16, 4, v13
  v_lshl_add_u32 v16, v15, 2, v16
  v_add_u32 v16, 57344, v16
  ds_read_b32 v24, v16
  ds_read_b32 v25, v16 offset:64
  ds_read_b32 v26, v16 offset:128
  ds_read_b32 v27, v16 offset:192
  s_waitcnt lgkmcnt(0)
  v_add_f32 v24, v24, v25
  v_add_f32 v26, v26, v27
  v_add_f32 v24, v24, v26
  v_cvt_pk_bf16_f32 v24, v24, v24
  s_mul_i32 s48, s44, 448
  s_mul_i32 s49, s46, 112
  s_add_u32 s48, s48, s49
  s_add_u32 s48, s48, s47
  s_lshl_b32 s48, s48, 1
  v_mul_u32_u24 v16, 1792, v15
  v_lshl_add_u32 v16, v13, 1, v16
  v_add_u32 v16, s48, v16
  s_mov_b64 exec, 0xffff
  global_store_short v16, v24, s[28:29]
  s_mov_b64 exec, -1
  s_cmp_eq_u32 s2, 0
  s_cbranch_scc0 L_done_m
  v_mov_b32 v24, s6
  v_mov_b32 v25, 0
  s_mov_b64 exec, 1
  global_store_dword v25, v24, s[24:25] sc1
  s_mov_b64 exec, -1
  s_waitcnt vmcnt(0)
  s_branch L_done_m
L_aux_m:
  v_mov_b32 v0, v6
  s_setprio 3
  v_lshrrev_b32 v1, 2, v0
  v_lshlrev_b32 v1, 13, v1
  v_and_b32 v2, 3, v0
  v_lshlrev_b32 v3, 4, v2
  v_add_u32 v1, v1, v3
  v_mul_u32_u24 v4, 896, v2
  v_lshrrev_b32 v5, 4, v0
  v_lshlrev_b32 v6, 4, v5
  v_add_u32 v4, v4, v6
  s_and_b32 s45, s82, 127
  s_lshl_b32 s45, s45, 6
  s_and_b32 s49, s49, 0xffff
  s_mov_b32 s50, 3584
  s_mov_b32 s51, 0x20000
  s_and_b32 s53, s53, 0xffff
  s_mov_b32 s54, 3670016
  s_mov_b32 s55, 0x20000
  s_mov_b32 m0, 0
  s_nop 0
  buffer_load_dwordx4 v[16:19], v4, s[48:51], 0 offen offset:0
  buffer_load_dwordx4 v[20:23], v4, s[48:51], 0 offen offset:64
  buffer_load_dwordx4 v[24:27], v4, s[48:51], 0 offen offset:128
  buffer_load_dwordx4 v[28:31], v4, s[48:51], 0 offen offset:192
  buffer_load_dwordx4 v[32:35], v4, s[48:51], 0 offen offset:256
  buffer_load_dwordx4 v[36:39], v4, s[48:51], 0 offen offset:320
  buffer_load_dwordx4 v[40:43], v4, s[48:51], 0 offen offset:384
  buffer_load_dwordx4 v[44:47], v4, s[48:51], 0 offen offset:448
  buffer_load_dwordx4 v[48:51], v4, s[48:51], 0 offen offset:512
  buffer_load_dwordx4 v[52:55], v4, s[48:51], 0 offen offset:576
  buffer_load_dwordx4 v[56:59], v4, s[48:51], 0 offen offset:640
  buffer_load_dwordx4 v[60:63], v4, s[48:51], 0 offen offset:704
  buffer_load_dwordx4 v[64:67], v4, s[48:51], 0 offen offset:768
  buffer_load_dwordx4 v[68:71], v4, s[48:51], 0 offen offset:832
  buffer_load_dwordx4 v1, s[52:55], s45 offen nt lds
  s_add_u32 s45, s45, 131072
  s_add_u32 m0, m0, 1024
  s_nop 0
  buffer_load_dwordx4 v1, s[52:55], s45 offen nt lds
  s_add_u32 s45, s45, 131072
  s_add_u32 m0, m0, 1024
  s_nop 0
  buffer_load_dwordx4 v1, s[52:55], s45 offen nt lds
  s_add_u32 s45, s45, 131072
  s_add_u32 m0, m0, 1024
  s_nop 0
  buffer_load_dwordx4 v1, s[52:55], s45 offen nt lds
  s_add_u32 s45, s45, 131072
  s_add_u32 m0, m0, 1024
  s_nop 0
  buffer_load_dwordx4 v1, s[52:55], s45 offen nt lds
  s_add_u32 s45, s45, 131072
  s_add_u32 m0, m0, 1024
  s_nop 0
  buffer_load_dwordx4 v1, s[52:55], s45 offen nt lds
  s_add_u32 s45, s45, 131072
  s_add_u32 m0, m0, 1024
  s_nop 0
  buffer_load_dwordx4 v1, s[52:55], s45 offen nt lds
  s_add_u32 s45, s45, 131072
  s_add_u32 m0, m0, 1024
  s_nop 0
  buffer_load_dwordx4 v1, s[52:55], s45 offen nt lds
  s_add_u32 s45, s45, 131072
  s_add_u32 m0, m0, 1024
  s_nop 0
  buffer_load_dwordx4 v1, s[52:55], s45 offen nt lds
  s_add_u32 s45, s45, 131072
  s_add_u32 m0, m0, 1024
  s_nop 0
  buffer_load_dwordx4 v1, s[52:55], s45 offen nt lds
  s_add_u32 s45, s45, 131072
  s_add_u32 m0, m0, 1024
  s_nop 0
  buffer_load_dwordx4 v1, s[52:55], s45 offen nt lds
  s_add_u32 s45, s45, 131072
  s_add_u32 m0, m0, 1024
  s_nop 0
  buffer_load_dwordx4 v1, s[52:55], s45 offen nt lds
  s_add_u32 s45, s45, 131072
  s_add_u32 m0, m0, 1024
  s_nop 0
  buffer_load_dwordx4 v1, s[52:55], s45 offen nt lds
  s_add_u32 s45, s45, 131072
  s_add_u32 m0, m0, 1024
  s_nop 0
  buffer_load_dwordx4 v1, s[52:55], s45 offen nt lds
  s_add_u32 s45, s45, 131072
  s_add_u32 m0, m0, 1024
  s_nop 0
  buffer_load_dwordx4 v1, s[52:55], s45 offen nt lds
  s_add_u32 s45, s45, 131072
  s_add_u32 m0, m0, 1024
  s_nop 0
  buffer_load_dwordx4 v1, s[52:55], s45 offen nt lds
  s_add_u32 s45, s45, 131072
  s_add_u32 m0, m0, 1024
  s_nop 0
  buffer_load_dwordx4 v1, s[52:55], s45 offen nt lds
  s_add_u32 s45, s45, 131072
  s_add_u32 m0, m0, 1024
  s_nop 0
  buffer_load_dwordx4 v1, s[52:55], s45 offen nt lds
  s_add_u32 s45, s45, 131072
  s_add_u32 m0, m0, 1024
  s_nop 0
  buffer_load_dwordx4 v1, s[52:55], s45 offen nt lds
  s_add_u32 s45, s45, 131072
  s_add_u32 m0, m0, 1024
  s_nop 0
  buffer_load_dwordx4 v1, s[52:55], s45 offen nt lds
  s_add_u32 s45, s45, 131072
  s_add_u32 m0, m0, 1024
  s_nop 0
  buffer_load_dwordx4 v1, s[52:55], s45 offen nt lds
  s_add_u32 s45, s45, 131072
  s_add_u32 m0, m0, 1024
  s_nop 0
  buffer_load_dwordx4 v1, s[52:55], s45 offen nt lds
  s_add_u32 s45, s45, 131072
  s_add_u32 m0, m0, 1024
  s_nop 0
  buffer_load_dwordx4 v1, s[52:55], s45 offen nt lds
  s_add_u32 s45, s45, 131072
  s_add_u32 m0, m0, 1024
  s_nop 0
  buffer_load_dwordx4 v1, s[52:55], s45 offen nt lds
  s_add_u32 s45, s45, 131072
  s_add_u32 m0, m0, 1024
  s_nop 0
  buffer_load_dwordx4 v1, s[52:55], s45 offen nt lds
  s_add_u32 s45, s45, 131072
  s_add_u32 m0, m0, 1024
  s_nop 0
  buffer_load_dwordx4 v1, s[52:55], s45 offen nt lds
  s_add_u32 s45, s45, 131072
  s_add_u32 m0, m0, 1024
  s_nop 0
  buffer_load_dwordx4 v1, s[52:55], s45 offen nt lds
  s_add_u32 s45, s45, 131072
  s_add_u32 m0, m0, 1024
  s_nop 0
  buffer_load_dwordx4 v1, s[52:55], s45 offen nt lds
  s_waitcnt vmcnt(8)
  s_barrier
  s_waitcnt lgkmcnt(0)
  s_add_u32 s6, s6, 1
  s_and_b32 s44, s6, 0xff
  s_add_u32 s7, s44, 0x35
  s_and_b32 s7, s7, 0xff
  s_lshl_b32 s7, s7, 8
  s_or_b32 s7, s7, s44
  s_add_u32 s45, s44, 0x6b
  s_and_b32 s45, s45, 0xff
  s_lshl_b32 s45, s45, 16
  s_or_b32 s7, s7, s45
  s_add_u32 s45, s44, 0xa1
  s_lshl_b32 s45, s45, 24
  s_or_b32 s7, s7, s45
  v_lshlrev_b32 v76, 2, v0
  v_mov_b32 v77, -1
  v_add_u32 v78, 55808, v76
  ds_write_b32 v78, v77
  ds_write_b32 v78, v77 offset:256
  v_lshlrev_b32 v76, 2, v0
  v_mov_b32 v77, 0
  v_add_u32 v78, 55552, v76
  s_mov_b64 exec, 0xffff
  ds_write_b32 v78, v77
  s_mov_b64 exec, -1
  s_waitcnt lgkmcnt(0)
  v_mov_b32 v77, 8
  v_mov_b32 v78, 55568
  ds_write_b32 v78, v77
  v_lshrrev_b32 v6, 2, v0
  v_and_b32 v6, 3, v6
  v_lshl_add_u32 v6, v5, 3, v6
  v_lshlrev_b32 v6, 6, v6
  v_lshl_add_u32 v6, v2, 3, v6
  v_add_u32 v6, 0, v6
  s_waitcnt vmcnt(0)
  ds_read_b64_tr_b16 v[72:73], v6 offset:0
  ds_read_b64_tr_b16 v[74:75], v6 offset:256
  ds_read_b64_tr_b16 v[76:77], v6 offset:32
  ds_read_b64_tr_b16 v[78:79], v6 offset:288
  ds_read_b64_tr_b16 v[80:81], v6 offset:2048
  ds_read_b64_tr_b16 v[82:83], v6 offset:2304
  ds_read_b64_tr_b16 v[84:85], v6 offset:2080
  ds_read_b64_tr_b16 v[86:87], v6 offset:2336
  ds_read_b64_tr_b16 v[88:89], v6 offset:4096
  ds_read_b64_tr_b16 v[90:91], v6 offset:4352
  ds_read_b64_tr_b16 v[92:93], v6 offset:4128
  ds_read_b64_tr_b16 v[94:95], v6 offset:4384
  ds_read_b64_tr_b16 v[96:97], v6 offset:6144
  ds_read_b64_tr_b16 v[98:99], v6 offset:6400
  ds_read_b64_tr_b16 v[100:101], v6 offset:6176
  ds_read_b64_tr_b16 v[102:103], v6 offset:6432
  ds_read_b64_tr_b16 v[104:105], v6 offset:8192
  ds_read_b64_tr_b16 v[106:107], v6 offset:8448
  ds_read_b64_tr_b16 v[108:109], v6 offset:8224
  ds_read_b64_tr_b16 v[110:111], v6 offset:8480
  ds_read_b64_tr_b16 v[112:113], v6 offset:10240
  ds_read_b64_tr_b16 v[114:115], v6 offset:10496
  ds_read_b64_tr_b16 v[116:117], v6 offset:10272
  ds_read_b64_tr_b16 v[118:119], v6 offset:10528
  ds_read_b64_tr_b16 v[120:121], v6 offset:12288
  ds_read_b64_tr_b16 v[122:123], v6 offset:12544
  ds_read_b64_tr_b16 v[124:125], v6 offset:12320
  ds_read_b64_tr_b16 v[126:127], v6 offset:12576
  s_waitcnt lgkmcnt(0)
  v_mfma_f32_16x16x32_bf16 v[8:11], v[16:19], v[72:75], 0
  v_mfma_f32_16x16x32_bf16 v[12:15], v[16:19], v[76:79], 0
  v_mfma_f32_16x16x32_bf16 v[8:11], v[20:23], v[80:83], v[8:11]
  v_mfma_f32_16x16x32_bf16 v[12:15], v[20:23], v[84:87], v[12:15]
  v_mfma_f32_16x16x32_bf16 v[8:11], v[24:27], v[88:91], v[8:11]
  v_mfma_f32_16x16x32_bf16 v[12:15], v[24:27], v[92:95], v[12:15]
  v_mfma_f32_16x16x32_bf16 v[8:11], v[28:31], v[96:99], v[8:11]
  v_mfma_f32_16x16x32_bf16 v[12:15], v[28:31], v[100:103], v[12:15]
  v_mfma_f32_16x16x32_bf16 v[8:11], v[32:35], v[104:107], v[8:11]
  v_mfma_f32_16x16x32_bf16 v[12:15], v[32:35], v[108:111], v[12:15]
  v_mfma_f32_16x16x32_bf16 v[8:11], v[36:39], v[112:115], v[8:11]
  v_mfma_f32_16x16x32_bf16 v[12:15], v[36:39], v[116:119], v[12:15]
  v_mfma_f32_16x16x32_bf16 v[8:11], v[40:43], v[120:123], v[8:11]
  v_mfma_f32_16x16x32_bf16 v[12:15], v[40:43], v[124:127], v[12:15]
  ds_read_b64_tr_b16 v[72:73], v6 offset:14336
  ds_read_b64_tr_b16 v[74:75], v6 offset:14592
  ds_read_b64_tr_b16 v[76:77], v6 offset:14368
  ds_read_b64_tr_b16 v[78:79], v6 offset:14624
  ds_read_b64_tr_b16 v[80:81], v6 offset:16384
  ds_read_b64_tr_b16 v[82:83], v6 offset:16640
  ds_read_b64_tr_b16 v[84:85], v6 offset:16416
  ds_read_b64_tr_b16 v[86:87], v6 offset:16672
  ds_read_b64_tr_b16 v[88:89], v6 offset:18432
  ds_read_b64_tr_b16 v[90:91], v6 offset:18688
  ds_read_b64_tr_b16 v[92:93], v6 offset:18464
  ds_read_b64_tr_b16 v[94:95], v6 offset:18720
  ds_read_b64_tr_b16 v[96:97], v6 offset:20480
  ds_read_b64_tr_b16 v[98:99], v6 offset:20736
  ds_read_b64_tr_b16 v[100:101], v6 offset:20512
  ds_read_b64_tr_b16 v[102:103], v6 offset:20768
  ds_read_b64_tr_b16 v[104:105], v6 offset:22528
  ds_read_b64_tr_b16 v[106:107], v6 offset:22784
  ds_read_b64_tr_b16 v[108:109], v6 offset:22560
  ds_read_b64_tr_b16 v[110:111], v6 offset:22816
  ds_read_b64_tr_b16 v[112:113], v6 offset:24576
  ds_read_b64_tr_b16 v[114:115], v6 offset:24832
  ds_read_b64_tr_b16 v[116:117], v6 offset:24608
  ds_read_b64_tr_b16 v[118:119], v6 offset:24864
  ds_read_b64_tr_b16 v[120:121], v6 offset:26624
  ds_read_b64_tr_b16 v[122:123], v6 offset:26880
  ds_read_b64_tr_b16 v[124:125], v6 offset:26656
  ds_read_b64_tr_b16 v[126:127], v6 offset:26912
  s_waitcnt lgkmcnt(0)
  v_mfma_f32_16x16x32_bf16 v[8:11], v[44:47], v[72:75], v[8:11]
  v_mfma_f32_16x16x32_bf16 v[12:15], v[44:47], v[76:79], v[12:15]
  v_mfma_f32_16x16x32_bf16 v[8:11], v[48:51], v[80:83], v[8:11]
  v_mfma_f32_16x16x32_bf16 v[12:15], v[48:51], v[84:87], v[12:15]
  v_mfma_f32_16x16x32_bf16 v[8:11], v[52:55], v[88:91], v[8:11]
  v_mfma_f32_16x16x32_bf16 v[12:15], v[52:55], v[92:95], v[12:15]
  v_mfma_f32_16x16x32_bf16 v[8:11], v[56:59], v[96:99], v[8:11]
  v_mfma_f32_16x16x32_bf16 v[12:15], v[56:59], v[100:103], v[12:15]
  v_mfma_f32_16x16x32_bf16 v[8:11], v[60:63], v[104:107], v[8:11]
  v_mfma_f32_16x16x32_bf16 v[12:15], v[60:63], v[108:111], v[12:15]
  v_mfma_f32_16x16x32_bf16 v[8:11], v[64:67], v[112:115], v[8:11]
  v_mfma_f32_16x16x32_bf16 v[12:15], v[64:67], v[116:119], v[12:15]
  v_mfma_f32_16x16x32_bf16 v[8:11], v[68:71], v[120:123], v[8:11]
  v_mfma_f32_16x16x32_bf16 v[12:15], v[68:71], v[124:127], v[12:15]
  s_nop 7
  v_cmp_eq_u32 vcc, 1, v5
  v_cmp_eq_u32 s[56:57], 2, v5
  v_cmp_eq_u32 s[58:59], 3, v5
  s_nop 1
  v_cndmask_b32 v8, v8, v9, vcc
  v_cndmask_b32 v12, v12, v13, vcc
  v_cndmask_b32 v8, v8, v10, s[56:57]
  v_cndmask_b32 v12, v12, v14, s[56:57]
  v_cndmask_b32 v8, v8, v11, s[58:59]
  v_cndmask_b32 v12, v12, v15, s[58:59]
  v_and_b32 v7, 1, v0
  v_cmp_eq_u32 vcc, 0, v7
  v_mov_b32 v9, 0
  v_mov_b32 v13, 0
  s_nop 1
  v_mov_b32_dpp v9, v8 row_shl:1 row_mask:0xf bank_mask:0xf
  v_mov_b32_dpp v13, v12 row_shr:1 row_mask:0xf bank_mask:0xf
  s_nop 1
  v_cndmask_b32 v10, v13, v8, vcc
  v_cndmask_b32 v11, v12, v9, vcc
  v_cvt_pk_bf16_f32 v10, v10, v11
  v_mov_b32 v11, s6
  s_lshr_b32 s44, s82, 7
  s_lshl_b32 s44, s44, 16
  s_lshr_b32 s45, s82, 3
  s_and_b32 s45, s45, 15
  s_lshl_b32 s45, s45, 10
  s_add_u32 s44, s44, s45
  s_and_b32 s45, s82, 7
  s_lshl_b32 s45, s45, 7
  s_add_u32 s44, s44, s45
  s_add_u32 s44, s44, 4096
  v_lshlrev_b32 v12, 14, v5
  v_lshlrev_b32 v13, 6, v7
  v_add_u32 v12, v12, v13
  v_and_b32 v13, 15, v0
  v_lshrrev_b32 v13, 1, v13
  v_lshl_add_u32 v12, v13, 3, v12
  v_add_u32 v12, s44, v12
  global_store_dwordx2 v12, v[10:11], s[24:25] sc1
  s_lshl_b32 s44, s4, 11
  s_add_u32 s44, s44, 4096
  v_lshlrev_b32 v1, 4, v0
  v_add_u32 v1, s44, v1
  v_add_u32 v2, 0x10000, v1
  v_lshlrev_b32 v3, 3, v0
  v_add_u32 v3, 28672, v3
  s_mov_b32 s45, 0
  global_load_dwordx4 v[8:11], v2, s[24:25] sc1
  s_sleep 2
  global_load_dwordx4 v[12:15], v2, s[24:25] sc1
  s_sleep 2
  global_load_dwordx4 v[16:19], v2, s[24:25] sc1
  s_sleep 2
  global_load_dwordx4 v[20:23], v2, s[24:25] sc1
  s_sleep 2
  global_load_dwordx4 v[24:27], v2, s[24:25] sc1
  s_sleep 2
  global_load_dwordx4 v[28:31], v2, s[24:25] sc1
L_qg_loop_m:
  s_waitcnt vmcnt(5)
  v_xor_b32 v4, s6, v9
  v_xor_b32 v5, s6, v11
  v_or_b32 v4, v4, v5
  v_cmp_ne_u32 vcc, 0, v4
  s_cbranch_vccz L_qg_ok0_m
  global_load_dwordx4 v[8:11], v2, s[24:25] sc1
  s_waitcnt vmcnt(5)
  v_xor_b32 v4, s6, v13
  v_xor_b32 v5, s6, v15
  v_or_b32 v4, v4, v5
  v_cmp_ne_u32 vcc, 0, v4
  s_cbranch_vccz L_qg_ok1_m
  global_load_dwordx4 v[12:15], v2, s[24:25] sc1
  s_waitcnt vmcnt(5)
  v_xor_b32 v4, s6, v17
  v_xor_b32 v5, s6, v19
  v_or_b32 v4, v4, v5
  v_cmp_ne_u32 vcc, 0, v4
  s_cbranch_vccz L_qg_ok2_m
  global_load_dwordx4 v[16:19], v2, s[24:25] sc1
  s_waitcnt vmcnt(5)
  v_xor_b32 v4, s6, v21
  v_xor_b32 v5, s6, v23
  v_or_b32 v4, v4, v5
  v_cmp_ne_u32 vcc, 0, v4
  s_cbranch_vccz L_qg_ok3_m
  global_load_dwordx4 v[20:23], v2, s[24:25] sc1
  s_waitcnt vmcnt(5)
  v_xor_b32 v4, s6, v25
  v_xor_b32 v5, s6, v27
  v_or_b32 v4, v4, v5
  v_cmp_ne_u32 vcc, 0, v4
  s_cbranch_vccz L_qg_ok4_m
  global_load_dwordx4 v[24:27], v2, s[24:25] sc1
  s_waitcnt vmcnt(5)
  v_xor_b32 v4, s6, v29
  v_xor_b32 v5, s6, v31
  v_or_b32 v4, v4, v5
  v_cmp_ne_u32 vcc, 0, v4
  s_cbranch_vccz L_qg_ok5_m
  global_load_dwordx4 v[28:31], v2, s[24:25] sc1
  s_add_u32 s45, s45, 1
  s_cmp_gt_u32 s45, 200000
  s_cbranch_scc1 L_fail_aux_m
  s_branch L_qg_loop_m
L_qg_ok0_m:
  v_mov_b32 v9, v10
  ds_write_b64 v3, v[8:9]
  s_branch L_qg_first_m
L_qg_ok1_m:
  v_mov_b32 v13, v14
  ds_write_b64 v3, v[12:13]
  s_branch L_qg_first_m
L_qg_ok2_m:
  v_mov_b32 v17, v18
  ds_write_b64 v3, v[16:17]
  s_branch L_qg_first_m
L_qg_ok3_m:
  v_mov_b32 v21, v22
  ds_write_b64 v3, v[20:21]
  s_branch L_qg_first_m
L_qg_ok4_m:
  v_mov_b32 v25, v26
  ds_write_b64 v3, v[24:25]
  s_branch L_qg_first_m
L_qg_ok5_m:
  v_mov_b32 v29, v30
  ds_write_b64 v3, v[28:29]
  s_branch L_qg_first_m
L_qg_first_m:
  s_waitcnt lgkmcnt(0)
  s_barrier
  s_waitcnt vmcnt(0)
  s_mov_b32 s45, 0
L_qg2_poll_m:
  global_load_dwordx4 v[12:15], v2, s[24:25] offset:1024 sc1
  global_load_dwordx4 v[16:19], v1, s[24:25] sc1
  global_load_dwordx4 v[20:23], v1, s[24:25] offset:1024 sc1
  s_waitcnt vmcnt(0)
  v_xor_b32 v13, s6, v13
  v_xor_b32 v15, s6, v15
  v_xor_b32 v17, s6, v17
  v_xor_b32 v19, s6, v19
  v_xor_b32 v21, s6, v21
  v_xor_b32 v23, s6, v23
  v_or3_b32 v13, v13, v15, v17
  v_or3_b32 v13, v13, v19, v21
  v_or_b32 v13, v13, v23
  v_cmp_ne_u32 vcc, 0, v13
  s_cbranch_vccz L_qg2_ok_m
  s_add_u32 s45, s45, 1
  s_cmp_gt_u32 s45, 200000
  s_cbranch_scc1 L_fail_aux_m
  s_sleep 8
  s_branch L_qg2_poll_m
L_qg2_ok_m:
  v_mov_b32 v13, v14
  v_mov_b32 v17, v18
  v_mov_b32 v21, v22
  ds_write_b64 v3, v[12:13] offset:512
  ds_write_b64 v3, v[16:17] offset:1024
  ds_write_b64 v3, v[20:21] offset:1536
  s_waitcnt lgkmcnt(0)
  v_mov_b32 v4, 55572
  v_mov_b32 v5, 1
  ds_write_b32 v4, v5
  s_lshl_b32 s44, s4, 2
  s_mul_i32 s44, s44, 4352
  s_add_u32 s44, s44, 2359296
  v_and_b32 v72, 3, v0
  v_mul_u32_u24 v72, 4352, v72
  v_add_u32 v72, s44, v72
  s_cmp_eq_u32 s5, 0
  s_cbranch_scc0 L_noinit_m
  v_mov_b32 v74, 0
  v_mov_b32 v75, s6
  s_mov_b64 exec, 0xf
  global_store_dwordx2 v72, v[74:75], s[24:25] sc1
  s_mov_b64 exec, -1
L_noinit_m:
  s_mov_b32 s53, 0
L_cinit_m:
  global_load_dwordx2 v[74:75], v72, s[24:25] sc1
  s_waitcnt vmcnt(0)
  v_cmp_ne_u32 vcc, s6, v75
  s_cbranch_vccz L_cinit_ok_m
  s_add_u32 s53, s53, 1
  s_cmp_gt_u32 s53, 200000
  s_cbranch_scc1 L_fail_aux_m
  s_sleep 8
  s_branch L_cinit_m
L_cinit_ok_m:
  v_mov_b32 v4, 55584
  v_mov_b32 v5, 1
  ds_write_b32 v4, v5
  v_mov_b32 v10, 55588
  s_mov_b32 s53, 0
L_endw_m:
  ds_read_b32 v11, v10
  s_waitcnt lgkmcnt(0)
  v_readfirstlane_b32 s44, v11
  s_nop 0
  s_cmp_ge_u32 s44, 1
  s_cbranch_scc1 L_endw_ok_m
  s_add_u32 s53, s53, 1
  s_cmp_gt_u32 s53, 1000000
  s_cbranch_scc1 L_fail_aux_m
  s_sleep 4
  s_branch L_endw_m
L_endw_ok_m:
  s_load_dwordx2 s[48:49], s[0:1], 32
  s_load_dwordx2 s[52:53], s[0:1], 72
  s_lshr_b32 s44, s83, 2
  s_mul_i32 s44, s44, 57344
  s_and_b32 s45, s83, 3
  s_mul_i32 s45, s45, 224
  s_add_u32 s44, s44, s45
  v_mul_u32_u24 v2, 4682, v0
  v_lshrrev_b32 v2, 16, v2
  v_mul_u32_u24 v3, 14, v2
  v_sub_u32 v3, v0, v3
  s_waitcnt lgkmcnt(0)
  s_and_b32 s49, s49, 0xffff
  s_mov_b32 s50, 3670016
  s_mov_b32 s51, 0x20000
  s_and_b32 s53, s53, 0xffff
  s_mov_b32 s54, 3670016
  s_mov_b32 s55, 0x20000
  v_mul_u32_u24 v4, 896, v2
  v_lshl_add_u32 v4, v3, 4, v4
  s_mov_b32 m0, 0
  s_nop 0
  buffer_load_dwordx4 v4, s[48:51], s44 offen nt lds
  s_mov_b32 m0, 14336
  s_nop 0
  buffer_load_dwordx4 v4, s[52:55], s44 offen nt lds
  v_add_u32 v3, 8, v3
  v_add_u32 v2, 4, v2
  v_cmp_le_u32 vcc, 14, v3
  v_subrev_u32 v5, 14, v3
  v_add_u32 v6, 1, v2
  v_cndmask_b32 v3, v3, v5, vcc
  v_cndmask_b32 v2, v2, v6, vcc
  v_mul_u32_u24 v4, 896, v2
  v_lshl_add_u32 v4, v3, 4, v4
  s_mov_b32 m0, 1024
  s_nop 0
  buffer_load_dwordx4 v4, s[48:51], s44 offen nt lds
  s_mov_b32 m0, 15360
  s_nop 0
  buffer_load_dwordx4 v4, s[52:55], s44 offen nt lds
  v_add_u32 v3, 8, v3
  v_add_u32 v2, 4, v2
  v_cmp_le_u32 vcc, 14, v3
  v_subrev_u32 v5, 14, v3
  v_add_u32 v6, 1, v2
  v_cndmask_b32 v3, v3, v5, vcc
  v_cndmask_b32 v2, v2, v6, vcc
  v_mul_u32_u24 v4, 896, v2
  v_lshl_add_u32 v4, v3, 4, v4
  s_mov_b32 m0, 2048
  s_nop 0
  buffer_load_dwordx4 v4, s[48:51], s44 offen nt lds
  s_mov_b32 m0, 16384
  s_nop 0
  buffer_load_dwordx4 v4, s[52:55], s44 offen nt lds
  v_add_u32 v3, 8, v3
  v_add_u32 v2, 4, v2
  v_cmp_le_u32 vcc, 14, v3
  v_subrev_u32 v5, 14, v3
  v_add_u32 v6, 1, v2
  v_cndmask_b32 v3, v3, v5, vcc
  v_cndmask_b32 v2, v2, v6, vcc
  v_mul_u32_u24 v4, 896, v2
  v_lshl_add_u32 v4, v3, 4, v4
  s_mov_b32 m0, 3072
  s_nop 0
  buffer_load_dwordx4 v4, s[48:51], s44 offen nt lds
  s_mov_b32 m0, 17408
  s_nop 0
  buffer_load_dwordx4 v4, s[52:55], s44 offen nt lds
  v_add_u32 v3, 8, v3
  v_add_u32 v2, 4, v2
  v_cmp_le_u32 vcc, 14, v3
  v_subrev_u32 v5, 14, v3
  v_add_u32 v6, 1, v2
  v_cndmask_b32 v3, v3, v5, vcc
  v_cndmask_b32 v2, v2, v6, vcc
  v_mul_u32_u24 v4, 896, v2
  v_lshl_add_u32 v4, v3, 4, v4
  s_mov_b32 m0, 4096
  s_nop 0
  buffer_load_dwordx4 v4, s[48:51], s44 offen nt lds
  s_mov_b32 m0, 18432
  s_nop 0
  buffer_load_dwordx4 v4, s[52:55], s44 offen nt lds
  v_add_u32 v3, 8, v3
  v_add_u32 v2, 4, v2
  v_cmp_le_u32 vcc, 14, v3
  v_subrev_u32 v5, 14, v3
  v_add_u32 v6, 1, v2
  v_cndmask_b32 v3, v3, v5, vcc
  v_cndmask_b32 v2, v2, v6, vcc
  v_mul_u32_u24 v4, 896, v2
  v_lshl_add_u32 v4, v3, 4, v4
  s_mov_b32 m0, 5120
  s_nop 0
  buffer_load_dwordx4 v4, s[48:51], s44 offen nt lds
  s_mov_b32 m0, 19456
  s_nop 0
  buffer_load_dwordx4 v4, s[52:55], s44 offen nt lds
  v_add_u32 v3, 8, v3
  v_add_u32 v2, 4, v2
  v_cmp_le_u32 vcc, 14, v3
  v_subrev_u32 v5, 14, v3
  v_add_u32 v6, 1, v2
  v_cndmask_b32 v3, v3, v5, vcc
  v_cndmask_b32 v2, v2, v6, vcc
  v_mul_u32_u24 v4, 896, v2
  v_lshl_add_u32 v4, v3, 4, v4
  s_mov_b32 m0, 6144
  s_nop 0
  buffer_load_dwordx4 v4, s[48:51], s44 offen nt lds
  s_mov_b32 m0, 20480
  s_nop 0
  buffer_load_dwordx4 v4, s[52:55], s44 offen nt lds
  v_add_u32 v3, 8, v3
  v_add_u32 v2, 4, v2
  v_cmp_le_u32 vcc, 14, v3
  v_subrev_u32 v5, 14, v3
  v_add_u32 v6, 1, v2
  v_cndmask_b32 v3, v3, v5, vcc
  v_cndmask_b32 v2, v2, v6, vcc
  v_mul_u32_u24 v4, 896, v2
  v_lshl_add_u32 v4, v3, 4, v4
  s_mov_b32 m0, 7168
  s_nop 0
  buffer_load_dwordx4 v4, s[48:51], s44 offen nt lds
  s_mov_b32 m0, 21504
  s_nop 0
  buffer_load_dwordx4 v4, s[52:55], s44 offen nt lds
  v_add_u32 v3, 8, v3
  v_add_u32 v2, 4, v2
  v_cmp_le_u32 vcc, 14, v3
  v_subrev_u32 v5, 14, v3
  v_add_u32 v6, 1, v2
  v_cndmask_b32 v3, v3, v5, vcc
  v_cndmask_b32 v2, v2, v6, vcc
  v_mul_u32_u24 v4, 896, v2
  v_lshl_add_u32 v4, v3, 4, v4
  s_mov_b32 m0, 8192
  s_nop 0
  buffer_load_dwordx4 v4, s[48:51], s44 offen nt lds
  s_mov_b32 m0, 22528
  s_nop 0
  buffer_load_dwordx4 v4, s[52:55], s44 offen nt lds
  v_add_u32 v3, 8, v3
  v_add_u32 v2, 4, v2
  v_cmp_le_u32 vcc, 14, v3
  v_subrev_u32 v5, 14, v3
  v_add_u32 v6, 1, v2
  v_cndmask_b32 v3, v3, v5, vcc
  v_cndmask_b32 v2, v2, v6, vcc
  v_mul_u32_u24 v4, 896, v2
  v_lshl_add_u32 v4, v3, 4, v4
  s_mov_b32 m0, 9216
  s_nop 0
  buffer_load_dwordx4 v4, s[48:51], s44 offen nt lds
  s_mov_b32 m0, 23552
  s_nop 0
  buffer_load_dwordx4 v4, s[52:55], s44 offen nt lds
  v_add_u32 v3, 8, v3
  v_add_u32 v2, 4, v2
  v_cmp_le_u32 vcc, 14, v3
  v_subrev_u32 v5, 14, v3
  v_add_u32 v6, 1, v2
  v_cndmask_b32 v3, v3, v5, vcc
  v_cndmask_b32 v2, v2, v6, vcc
  v_mul_u32_u24 v4, 896, v2
  v_lshl_add_u32 v4, v3, 4, v4
  s_mov_b32 m0, 10240
  s_nop 0
  buffer_load_dwordx4 v4, s[48:51], s44 offen nt lds
  s_mov_b32 m0, 24576
  s_nop 0
  buffer_load_dwordx4 v4, s[52:55], s44 offen nt lds
  v_add_u32 v3, 8, v3
  v_add_u32 v2, 4, v2
  v_cmp_le_u32 vcc, 14, v3
  v_subrev_u32 v5, 14, v3
  v_add_u32 v6, 1, v2
  v_cndmask_b32 v3, v3, v5, vcc
  v_cndmask_b32 v2, v2, v6, vcc
  v_mul_u32_u24 v4, 896, v2
  v_lshl_add_u32 v4, v3, 4, v4
  s_mov_b32 m0, 11264
  s_nop 0
  buffer_load_dwordx4 v4, s[48:51], s44 offen nt lds
  s_mov_b32 m0, 25600
  s_nop 0
  buffer_load_dwordx4 v4, s[52:55], s44 offen nt lds
  v_add_u32 v3, 8, v3
  v_add_u32 v2, 4, v2
  v_cmp_le_u32 vcc, 14, v3
  v_subrev_u32 v5, 14, v3
  v_add_u32 v6, 1, v2
  v_cndmask_b32 v3, v3, v5, vcc
  v_cndmask_b32 v2, v2, v6, vcc
  v_mul_u32_u24 v4, 896, v2
  v_lshl_add_u32 v4, v3, 4, v4
  s_mov_b32 m0, 12288
  s_nop 0
  buffer_load_dwordx4 v4, s[48:51], s44 offen nt lds
  s_mov_b32 m0, 26624
  s_nop 0
  buffer_load_dwordx4 v4, s[52:55], s44 offen nt lds
  v_add_u32 v3, 8, v3
  v_add_u32 v2, 4, v2
  v_cmp_le_u32 vcc, 14, v3
  v_subrev_u32 v5, 14, v3
  v_add_u32 v6, 1, v2
  v_cndmask_b32 v3, v3, v5, vcc
  v_cndmask_b32 v2, v2, v6, vcc
  v_mul_u32_u24 v4, 896, v2
  v_lshl_add_u32 v4, v3, 4, v4
  s_mov_b32 m0, 13312
  s_nop 0
  buffer_load_dwordx4 v4, s[48:51], s44 offen nt lds
  s_mov_b32 m0, 27648
  s_nop 0
  buffer_load_dwordx4 v4, s[52:55], s44 offen nt lds
  s_waitcnt vmcnt(0) lgkmcnt(0)
  s_branch L_done_m
L_fail_aux_m:
  v_mov_b32 v24, 0xdeae
  v_mov_b32 v25, 12
  s_mov_b64 exec, 1
  global_store_dword v25, v24, s[26:27]
  s_mov_b64 exec, -1
  s_branch L_done_m
L_fail_m:
  v_mov_b32 v24, 0xdead
  v_mov_b32 v25, 4
  s_mov_b64 exec, 1
  global_store_dword v25, v24, s[26:27]
  s_mov_b64 exec, -1
L_done_m:
L_exit_m:
  s_endpgm
.section .rodata,"a"
.p2align 6
.amdhsa_kernel concat_heads__gqa_block_cached__mha_block_cached__decode_kernel
  .amdhsa_next_free_vgpr 232
  .amdhsa_next_free_sgpr 96
  .amdhsa_accum_offset 136
  .amdhsa_group_segment_fixed_size 0
  .amdhsa_kernarg_size 104
  .amdhsa_user_sgpr_count 2
  .amdhsa_user_sgpr_kernarg_segment_ptr 1
  .amdhsa_system_sgpr_workgroup_id_x 1
  .amdhsa_float_denorm_mode_32 3
.end_amdhsa_kernel
```
